```python
import torch

def _softmax(x, axis=-1):
    return torch.softmax(x, dim=axis)
def _gelu(x):
    return torch.nn.functional.gelu(x, approximate="tanh")
def _silu(x):
    return torch.nn.functional.silu(x)
def _sigmoid(x):
    return torch.sigmoid(x)
def _layernorm(x, axis=-1, eps=1e-5):
    m = x.mean(dim=axis, keepdim=True)
    v = x.var(dim=axis, keepdim=True, unbiased=False)
    return (x - m) / torch.sqrt(v + eps)
def _scatter_add(tgt, idx, src, axis=0):
    return tgt.clone().index_add_(axis, idx, src)
def _segment_sum(src, seg, n):
    out = torch.zeros((n,) + src.shape[1:], dtype=src.dtype)
    return out.index_add_(0, seg, src)
def _pad(x, pw):
    flat = tuple(v for pair in reversed(pw) for v in pair)
    return torch.nn.functional.pad(x, flat)

kernel_name = 'parallel_sum__spectral_gfnet__dense_activation_gelu__prompt'

def setup_inputs():

    _w = (lambda a: (lambda t: t.to(torch.bfloat16) if t.is_floating_point() else t)(torch.as_tensor(a)))
    def _A_setup():
        B, S, D = 1, 2048, 1024
        Df = D // 2 + 1
        return {
            "x": _w((lambda *s: torch.randn(*s, dtype=torch.bfloat16) * 0.05)(B, S, D)),
            "w_r": _w((lambda *s: torch.randn(*s, dtype=torch.bfloat16) * 0.4)(S, Df) * 0.02),
            "w_i": _w((lambda *s: torch.randn(*s, dtype=torch.bfloat16) * 0.4)(S, Df) * 0.02),
        }
    _A_in = _A_setup()

    def _B_setup():
        B, S, D, F = 1, 2048, 1024, 3584
        return {
            "x": _w((lambda *s: torch.randn(*s, dtype=torch.bfloat16) * 0.05)(B, S, D)),
            "w1": _w((lambda *s: torch.randn(*s, dtype=torch.bfloat16) * 0.4)(D, F) * (D ** -0.5)),
            "b1": _w((lambda *s: torch.randn(*s, dtype=torch.bfloat16) * 12.8)(F) * 0.01),
            "w2": _w((lambda *s: torch.randn(*s, dtype=torch.bfloat16) * 0.1)(F, D) * (F ** -0.5)),
            "b2": _w((lambda *s: torch.randn(*s, dtype=torch.bfloat16) * 1.6)(D) * 0.01),
        }
    _B_in = _B_setup()

    return {
        "A_x": _A_in["x"],
        "A_w_r": _A_in["w_r"],
        "A_w_i": _A_in["w_i"],
        "B_x": _B_in["x"],
        "B_w1": _B_in["w1"],
        "B_b1": _B_in["b1"],
        "B_w2": _B_in["w2"],
        "B_b2": _B_in["b2"],
    }

def reference(A_x, A_w_r, A_w_i, B_x, B_w1, B_b1, B_w2, B_b2):
    def _A_ref(x, w_r, w_i):
        B, S, D = x.shape
        X = (lambda x, axes=(-2,-1): torch.fft.rfft2(x.float(), dim=axes))(x, axes=(-2, -1))
        W = w_r + 1j * w_i
        X = X * W
        y = (lambda x, s, axes=(-2,-1): torch.fft.irfft2(x, s=s, dim=axes).to(torch.bfloat16))(X, (S, D), axes=(-2, -1))
        return y

    def _B_ref(x, w1, b1, w2, b2):
        h = torch.einsum("bsd,df->bsf", x, w1) + b1
        h = _gelu(h)
        return torch.einsum("bsf,fd->bsd", h, w2) + b2

    x = A_x
    xn = _layernorm(x, axis=-1)
    return x + _A_ref(xn, A_w_r, A_w_i) + _B_ref(xn, B_w1, B_b1, B_w2, B_b2)
```

```asm
; @launch grid=(256,1,1) block=(512,1,1) lds=163840
.amdgcn_target "amdgcn-amd-amdhsa--gfx950"
.text
.globl parallel_sum__spectral_gfnet__dense_activation_gelu__prompt_kernel
.p2align 8
.type parallel_sum__spectral_gfnet__dense_activation_gelu__prompt_kernel,@function
parallel_sum__spectral_gfnet__dense_activation_gelu__prompt_kernel:
    s_cmp_ge_u32 s2, 256
    s_cbranch_scc1 end_1
    s_load_dwordx16 s[64:79], s[0:1], 0
    s_load_dwordx4 s[80:83], s[0:1], 64
    s_load_dwordx2 s[84:85], s[0:1], 80
    v_lshrrev_b32 v1, 6, v0
    s_and_b32 s34, s2, 1
    s_bfe_u32 s32, s2, 0x20001
    v_readfirstlane_b32 s38, v1
    s_lshl_b32 s32, s32, 2
    s_lshr_b32 s33, s2, 6
    s_add_u32 s32, s32, s33
    s_bfe_u32 s33, s2, 0x30003
    s_lshl_b32 s36, s34, 3
    s_add_u32 s36, s36, s33
    s_xor_b32 s35, s2, s33
    s_and_b32 s35, s35, 1
    s_mul_i32 s35, s35, 9
    s_xor_b32 s35, s35, s2
    s_and_b32 s3, s38, 3
    s_lshr_b32 s37, s35, 5
    s_lshl_b32 s37, s37, 2
    s_add_u32 s37, s37, s3
    s_lshl_b32 s37, s37, 5
    s_and_b32 s39, s35, 31
    s_add_u32 s37, s37, s39
    s_cmp_ge_u32 s38, 4
    s_cbranch_scc1 yrole_2
    v_and_b32 v0, 63, v0
    v_lshrrev_b32 v33, 3, v0
    s_lshl_b32 s50, s3, 5
    v_add_u32 v33, s50, v33
    v_and_b32 v28, 7, v0
    v_add_u32 v29, 0, v33
    v_bfe_u32 v30, v29, 1, 3
    v_xor_b32 v30, v30, v28
    v_lshlrev_b32 v30, 4, v30
    v_lshl_add_u32 v207, v29, 11, v30
    v_add_u32 v29, 8, v33
    v_bfe_u32 v30, v29, 1, 3
    v_xor_b32 v30, v30, v28
    v_lshlrev_b32 v30, 4, v30
    v_lshl_add_u32 v208, v29, 11, v30
    v_subrev_u32 v208, 1024, v208
    v_add_u32 v29, 16, v33
    v_bfe_u32 v30, v29, 1, 3
    v_xor_b32 v30, v30, v28
    v_lshlrev_b32 v30, 4, v30
    v_lshl_add_u32 v209, v29, 11, v30
    v_subrev_u32 v209, 2048, v209
    v_add_u32 v29, 24, v33
    v_bfe_u32 v30, v29, 1, 3
    v_xor_b32 v30, v30, v28
    v_lshlrev_b32 v30, 4, v30
    v_lshl_add_u32 v210, v29, 11, v30
    v_subrev_u32 v210, 3072, v210
    v_lshrrev_b32 v33, 2, v0
    v_and_b32 v28, 3, v0
    v_lshlrev_b32 v28, 4, v28
    s_movk_i32 s51, 6720
    s_lshl_b32 s60, s32, 18
    s_mul_i32 s61, s36, 448
    s_mul_i32 s87, s3, 114688
    s_add_u32 s61, s61, s87
    s_and_b32 s62, s32, 12
    s_add_u32 s62, s62, 0
    s_lshl_b32 s94, s3, 12
    s_mul_i32 s87, s3, 7168
    s_add_u32 s87, s87, 16384
    s_and_b32 s62, s62, 15
    s_lshl_b32 s63, s62, 7
    s_add_u32 s63, s63, s60
    s_mul_i32 s86, s62, 458752
    s_add_u32 s86, s86, s61
    s_add_u32 s62, s62, 1
    v_add_u32 v29, 0, v33
    v_mul_u32_u24 v30, 147, v29
    v_lshrrev_b32 v30, 10, v30
    v_and_b32 v32, 8, v30
    v_lshlrev_b32 v32, 2, v32
    v_xor_b32 v32, v32, v28
    v_mad_u32_u24 v32, v30, s51, v32
    v_lshl_add_u32 v211, v33, 6, v32
    v_add_u32 v29, 16, v33
    v_mul_u32_u24 v30, 147, v29
    v_lshrrev_b32 v30, 10, v30
    v_and_b32 v32, 8, v30
    v_lshlrev_b32 v32, 2, v32
    v_xor_b32 v32, v32, v28
    v_mad_u32_u24 v32, v30, s51, v32
    v_lshl_add_u32 v212, v33, 6, v32
    v_add_u32 v29, 32, v33
    v_mul_u32_u24 v30, 147, v29
    v_lshrrev_b32 v30, 10, v30
    v_and_b32 v32, 8, v30
    v_lshlrev_b32 v32, 2, v32
    v_xor_b32 v32, v32, v28
    v_mad_u32_u24 v32, v30, s51, v32
    v_lshl_add_u32 v213, v33, 6, v32
    v_add_u32 v29, 48, v33
    v_mul_u32_u24 v30, 147, v29
    v_lshrrev_b32 v30, 10, v30
    v_and_b32 v32, 8, v30
    v_lshlrev_b32 v32, 2, v32
    v_xor_b32 v32, v32, v28
    v_mad_u32_u24 v32, v30, s51, v32
    v_lshl_add_u32 v214, v33, 6, v32
    v_add_u32 v29, 64, v33
    v_mul_u32_u24 v30, 147, v29
    v_lshrrev_b32 v30, 10, v30
    v_and_b32 v32, 8, v30
    v_lshlrev_b32 v32, 2, v32
    v_xor_b32 v32, v32, v28
    v_mad_u32_u24 v32, v30, s51, v32
    v_lshl_add_u32 v215, v33, 6, v32
    v_add_u32 v215, 4096, v215
    v_add_u32 v29, 80, v33
    v_mul_u32_u24 v30, 147, v29
    v_lshrrev_b32 v30, 10, v30
    v_and_b32 v32, 8, v30
    v_lshlrev_b32 v32, 2, v32
    v_xor_b32 v32, v32, v28
    v_mad_u32_u24 v32, v30, s51, v32
    v_lshl_add_u32 v216, v33, 6, v32
    v_add_u32 v216, 4096, v216
    v_add_u32 v29, 96, v33
    v_mul_u32_u24 v30, 147, v29
    v_lshrrev_b32 v30, 10, v30
    v_and_b32 v32, 8, v30
    v_lshlrev_b32 v32, 2, v32
    v_xor_b32 v32, v32, v28
    v_mad_u32_u24 v32, v30, s51, v32
    v_lshl_add_u32 v217, v33, 6, v32
    v_add_u32 v217, 4096, v217
    s_waitcnt lgkmcnt(0)
    s_mov_b32 s8, s64
    s_mov_b32 s9, s65
    s_mov_b32 s10, 4194304
    s_mov_b32 s11, 0x20000
    s_mov_b32 s16, s72
    s_mov_b32 s17, s73
    s_mov_b32 s18, 7340032
    s_mov_b32 s19, 0x20000
    s_add_u32 m0, s94, 0
    s_nop 0
    buffer_load_dwordx4 v207, s[8:11], s63 offen offset:0 lds
    v_and_b32 v60, 31, v0
    v_lshrrev_b32 v61, 5, v0
    s_lshl_b32 s52, s3, 3
    v_cvt_f32_u32 v62, v60
    v_lshl_add_u32 v63, v61, 2, s52
    v_cvt_f32_u32 v63, v63
    v_mul_f32 v62, 0x3d000000, v62
    v_lshlrev_b32 v240, 4, v0
    v_mul_f32 v63, v63, v62
    s_lshl_b32 s52, s3, 10
    s_add_u32 s53, s52, 152576
    s_add_u32 s52, s52, 135168
    v_mov_b32 v64, v63
    buffer_load_dwordx4 v208, s[8:11], s63 offen offset:1024 lds
    v_fmamk_f32 v65, v62, 0x3f800000, v63
    v_fmamk_f32 v66, v62, 0x40000000, v63
    v_fmamk_f32 v67, v62, 0x40400000, v63
    v_cos_f32 v68, v64
    v_sin_f32 v72, v64
    v_cos_f32 v69, v65
    buffer_load_dwordx4 v209, s[8:11], s63 offen offset:2048 lds
    v_sin_f32 v73, v65
    v_cos_f32 v70, v66
    v_sin_f32 v74, v66
    v_cos_f32 v71, v67
    v_sin_f32 v75, v67
    buffer_load_dwordx4 v210, s[8:11], s63 offen offset:3072 lds
    v_cvt_pk_bf16_f32 v80, v68, v72
    v_cvt_pk_bf16_f32 v84, -v72, v68
    v_cvt_pk_bf16_f32 v81, v69, v73
    v_cvt_pk_bf16_f32 v85, -v73, v69
    v_cvt_pk_bf16_f32 v82, v70, v74
    v_cvt_pk_bf16_f32 v86, -v74, v70
    v_cvt_pk_bf16_f32 v83, v71, v75
    v_cvt_pk_bf16_f32 v87, -v75, v71
    s_add_u32 m0, s87, 0
    s_nop 0
    buffer_load_dwordx4 v211, s[16:19], s86 offen offset:0 lds
    v_add_u32 v100, s53, v240
    v_add_u32 v101, s52, v240
    v_mul_f32 v102, 0x3d000000, v62
    v_mul_f32 v103, 0x3d000000, v63
    ds_write_b128 v100, v[80:83]
    ds_write_b128 v100, v[84:87] offset:4096
    v_mov_b32 v64, v103
    v_fmamk_f32 v65, v102, 0x3f800000, v103
    buffer_load_dwordx4 v212, s[16:19], s86 offen offset:1024 lds
    v_fmamk_f32 v66, v102, 0x40000000, v103
    v_fmamk_f32 v67, v102, 0x40400000, v103
    v_cos_f32 v88, v64
    v_sin_f32 v92, v64
    v_cos_f32 v89, v65
    v_sin_f32 v93, v65
    buffer_load_dwordx4 v213, s[16:19], s86 offen offset:2048 lds
    v_cos_f32 v90, v66
    v_sin_f32 v94, v66
    v_cos_f32 v91, v67
    v_sin_f32 v95, v67
    buffer_load_dwordx4 v214, s[16:19], s86 offen offset:3072 lds
    s_lshr_b32 s52, s3, 1
    s_and_b32 s53, s3, 1
    s_lshl_b32 s54, s52, 2
    s_add_u32 s54, s54, s53
    s_lshl_b32 s54, s54, 2
    v_lshl_add_u32 v63, v61, 3, s54
    v_cvt_f32_u32 v63, v63
    s_lshl_b32 s52, s52, 7
    s_add_u32 s52, s52, s53
    s_lshl_b32 s52, s52, 3
    s_add_u32 s52, s52, 143360
    v_mul_f32 v63, v63, v62
    ds_write_b128 v101, v[88:91]
    ds_write_b128 v101, v[92:95] offset:4096
    v_add_u32 v100, s52, v240
    s_add_u32 m0, s87, 4096
    s_nop 0
    buffer_load_dwordx4 v215, s[16:19], s86 offen offset:0 lds
    v_mov_b32 v64, v63
    v_fmamk_f32 v65, v62, 0x3f800000, v63
    v_fmamk_f32 v66, v62, 0x40000000, v63
    v_fmamk_f32 v67, v62, 0x40400000, v63
    v_cos_f32 v68, v64
    v_sin_f32 v72, v64
    v_cos_f32 v69, v65
    buffer_load_dwordx4 v216, s[16:19], s86 offen offset:1024 lds
    v_sin_f32 v73, v65
    v_cos_f32 v70, v66
    v_sin_f32 v74, v66
    v_cos_f32 v71, v67
    buffer_load_dwordx4 v217, s[16:19], s86 offen offset:2048 lds
    s_and_b32 s62, s62, 15
    s_lshl_b32 s63, s62, 7
    s_add_u32 s63, s63, s60
    s_mul_i32 s86, s62, 458752
    s_add_u32 s86, s86, s61
    s_add_u32 s62, s62, 1
    v_sin_f32 v75, v67
    v_cvt_pk_bf16_f32 v96, v68, v69
    v_cvt_pk_bf16_f32 v98, -v72, -v73
    v_cvt_pk_bf16_f32 v97, v70, v71
    v_cvt_pk_bf16_f32 v99, -v74, -v75
    ds_write_b64 v100, v[96:97]
    ds_write_b64 v100, v[98:99] offset:2048
    s_add_u32 m0, s94, 45056
    s_nop 0
    buffer_load_dwordx4 v207, s[8:11], s63 offen offset:0 lds
    s_and_b32 s43, s3, 1
    s_lshr_b32 s44, s3, 1
    v_mov_b32 v223, v0
    v_lshrrev_b32 v40, 4, v0
    v_bfe_u32 v41, v0, 2, 2
    buffer_load_dwordx4 v208, s[8:11], s63 offen offset:1024 lds
    v_lshl_add_u32 v41, v40, 3, v41
    v_mul_u32_u24 v41, 448, v41
    buffer_load_dwordx4 v209, s[8:11], s63 offen offset:2048 lds
    v_and_b32 v42, 3, v0
    v_lshl_add_u32 v41, v42, 3, v41
    v_add_u32 v41, 16384, v41
    buffer_load_dwordx4 v210, s[8:11], s63 offen offset:3072 lds
    v_and_b32 v42, 1, v40
    v_lshlrev_b32 v43, 5, v42
    s_lshl_b32 s51, s43, 8
    s_add_u32 m0, s87, 45056
    s_nop 0
    buffer_load_dwordx4 v211, s[16:19], s86 offen offset:0 lds
    v_add_u32 v44, s51, v41
    v_add_u32 v200, v44, v43
    v_sub_u32 v201, v44, v43
    buffer_load_dwordx4 v212, s[16:19], s86 offen offset:1024 lds
    v_xor_b32 v42, s43, v42
    v_lshl_add_u32 v202, v42, 5, v41
    v_add_u32 v202, 192, v202
    buffer_load_dwordx4 v213, s[16:19], s86 offen offset:2048 lds
    v_and_b32 v42, 15, v0
    v_bfe_u32 v43, v0, 1, 3
    buffer_load_dwordx4 v214, s[16:19], s86 offen offset:3072 lds
    v_xor_b32 v43, v43, v40
    v_lshlrev_b32 v43, 4, v43
    v_lshl_add_u32 v203, v42, 7, v43
    s_add_u32 m0, s87, 49152
    s_nop 0
    buffer_load_dwordx4 v215, s[16:19], s86 offen offset:0 lds
    s_lshl_b32 s51, s44, 13
    v_add_u32 v203, s51, v203
    v_xor_b32 v204, 64, v203
    buffer_load_dwordx4 v216, s[16:19], s86 offen offset:1024 lds
    s_lshl_b32 s50, s43, 13
    s_lshl_b32 s51, s44, 12
    s_add_u32 s50, s50, s51
    v_add_u32 v205, s50, v240
    s_lshl_b32 s50, s43, 9
    s_add_u32 s50, s50, s51
    v_lshl_add_u32 v206, v60, 4, s50
    buffer_load_dwordx4 v217, s[16:19], s86 offen offset:2048 lds
    s_and_b32 s62, s62, 15
    s_lshl_b32 s63, s62, 7
    s_add_u32 s63, s63, s60
    s_mul_i32 s86, s62, 458752
    s_add_u32 s86, s86, s61
    s_add_u32 s62, s62, 1
    v_lshl_add_u32 v206, v61, 10, v206
    v_lshlrev_b32 v247, 2, v60
    s_lshr_b32 s52, s2, 3
    s_lshl_b32 s52, s52, 2
    s_add_u32 s52, s52, s3
    s_lshl_b32 s53, s32, 6
    s_and_b32 s53, s53, 0x300
    s_cmp_lt_u32 s52, 64
    s_cselect_b64 exec, 0xfffffff, 1
    s_add_u32 s52, s52, s53
    s_add_u32 s52, s52, 192
    s_and_b32 s52, s52, 1023
    s_lshl_b32 s52, s52, 1
    s_add_u32 s52, s52, s34
    s_mul_i32 s52, s52, 3584
    v_lshlrev_b32 v218, 7, v0
    buffer_load_dword v219, v218, s[16:19], s52 offen
    s_mov_b64 exec, -1
    s_mov_b32 s51, 45056
    s_mov_b32 s50, 45056
    s_mov_b32 s46, 45056
    s_mov_b32 s47, 15
    s_setprio 2
    v_mov_b32 v48, 0
    v_mov_b32 v49, 0
    v_mov_b32 v50, 0
    v_mov_b32 v51, 0
    v_mov_b32 v52, 0
    v_mov_b32 v53, 0
    v_mov_b32 v54, 0
    v_mov_b32 v55, 0
    v_mov_b32 v56, 0
    v_mov_b32 v57, 0
    v_mov_b32 v58, 0
    v_mov_b32 v59, 0
    v_mov_b32 v60, 0
    v_mov_b32 v61, 0
    v_mov_b32 v62, 0
    v_mov_b32 v63, 0
    v_mov_b32 v64, 0
    v_mov_b32 v65, 0
    v_mov_b32 v66, 0
    v_mov_b32 v67, 0
    v_mov_b32 v68, 0
    v_mov_b32 v69, 0
    v_mov_b32 v70, 0
    v_mov_b32 v71, 0
    v_mov_b32 v72, 0
    v_mov_b32 v73, 0
    v_mov_b32 v74, 0
    v_mov_b32 v75, 0
    v_mov_b32 v76, 0
    v_mov_b32 v77, 0
    v_mov_b32 v78, 0
    v_mov_b32 v79, 0
    v_mov_b32 v80, 0
    v_mov_b32 v81, 0
    v_mov_b32 v82, 0
    v_mov_b32 v83, 0
    v_mov_b32 v84, 0
    v_mov_b32 v85, 0
    v_mov_b32 v86, 0
    v_mov_b32 v87, 0
    v_mov_b32 v88, 0
    v_mov_b32 v89, 0
    v_mov_b32 v90, 0
    v_mov_b32 v91, 0
    v_mov_b32 v92, 0
    v_mov_b32 v93, 0
    v_mov_b32 v94, 0
    v_mov_b32 v95, 0
    v_mov_b32 v96, 0
    v_mov_b32 v97, 0
    v_mov_b32 v98, 0
    v_mov_b32 v99, 0
    v_mov_b32 v100, 0
    v_mov_b32 v101, 0
    v_mov_b32 v102, 0
    v_mov_b32 v103, 0
    v_mov_b32 v104, 0
    v_mov_b32 v105, 0
    v_mov_b32 v106, 0
    v_mov_b32 v107, 0
    v_mov_b32 v108, 0
    v_mov_b32 v109, 0
    v_mov_b32 v110, 0
    v_mov_b32 v111, 0
    s_waitcnt vmcnt(12) lgkmcnt(0)
    s_barrier
    ds_read_b64_tr_b16 v[112:113], v200 offset:0
    ds_read_b64_tr_b16 v[114:115], v200 offset:1792
    ds_read_b64_tr_b16 v[156:157], v200 offset:14336
    ds_read_b64_tr_b16 v[158:159], v200 offset:16128
    ds_read_b128 v[140:143], v203 offset:0
    ds_read_b128 v[184:187], v204 offset:0
    ds_read_b64_tr_b16 v[116:117], v201 offset:32
    ds_read_b64_tr_b16 v[118:119], v201 offset:1824
    ds_read_b64_tr_b16 v[160:161], v201 offset:14368
    ds_read_b64_tr_b16 v[162:163], v201 offset:16160
    ds_read_b64_tr_b16 v[120:121], v200 offset:64
    ds_read_b64_tr_b16 v[122:123], v200 offset:1856
    ds_read_b64_tr_b16 v[164:165], v200 offset:14400
    ds_read_b64_tr_b16 v[166:167], v200 offset:16192
    ds_read_b128 v[144:147], v203 offset:2048
    ds_read_b128 v[188:191], v204 offset:2048
    ds_read_b128 v[148:151], v203 offset:4096
    ds_read_b128 v[192:195], v204 offset:4096
    s_add_u32 m0, s94, 90112
    s_nop 0
    buffer_load_dwordx4 v207, s[8:11], s63 offen offset:0 lds
    buffer_load_dwordx4 v208, s[8:11], s63 offen offset:1024 lds
    s_mov_b32 s88, 0
    s_mov_b32 s47, 13
    s_waitcnt lgkmcnt(12)
    v_mfma_f32_16x16x32_bf16 v[0:3], v[112:115], v[140:143], 0
    ds_read_b128 v[152:155], v203 offset:6144
    v_mfma_f32_16x16x32_bf16 v[0:3], v[156:159], v[184:187], v[0:3]
    buffer_load_dwordx4 v209, s[8:11], s63 offen offset:2048 lds
    ds_read_b128 v[196:199], v204 offset:6144
    s_waitcnt lgkmcnt(10)
    v_mfma_f32_16x16x32_bf16 v[16:19], v[116:119], v[140:143], 0
    ds_read_b64_tr_b16 v[124:125], v201 offset:96
    v_mfma_f32_16x16x32_bf16 v[16:19], v[160:163], v[184:187], v[16:19]
    buffer_load_dwordx4 v210, s[8:11], s63 offen offset:3072 lds
    ds_read_b64_tr_b16 v[126:127], v201 offset:1888
    s_waitcnt lgkmcnt(8)
    v_mfma_f32_16x16x32_bf16 v[32:35], v[120:123], v[140:143], 0
    ds_read_b64_tr_b16 v[168:169], v201 offset:14432
    v_mfma_f32_16x16x32_bf16 v[32:35], v[164:167], v[184:187], v[32:35]
    ds_read_b64_tr_b16 v[170:171], v201 offset:16224
    s_waitcnt lgkmcnt(8)
    v_mfma_f32_16x16x32_bf16 v[36:39], v[120:123], v[144:147], 0
    s_add_u32 m0, s87, 90112
    s_nop 0
    buffer_load_dwordx4 v211, s[16:19], s86 offen offset:0 lds
    ds_read_b64_tr_b16 v[128:129], v200 offset:128
    v_mfma_f32_16x16x32_bf16 v[36:39], v[164:167], v[188:191], v[36:39]
    ds_read_b64_tr_b16 v[130:131], v200 offset:1920
    v_mfma_f32_16x16x32_bf16 v[20:23], v[116:119], v[144:147], 0
    buffer_load_dwordx4 v212, s[16:19], s86 offen offset:1024 lds
    ds_read_b64_tr_b16 v[172:173], v200 offset:14464
    v_mfma_f32_16x16x32_bf16 v[20:23], v[160:163], v[188:191], v[20:23]
    ds_read_b64_tr_b16 v[174:175], v200 offset:16256
    v_mfma_f32_16x16x32_bf16 v[4:7], v[112:115], v[144:147], 0
    ds_read_b64_tr_b16 v[132:133], v201 offset:160
    v_mfma_f32_16x16x32_bf16 v[4:7], v[156:159], v[188:191], v[4:7]
    buffer_load_dwordx4 v213, s[16:19], s86 offen offset:2048 lds
    ds_read_b64_tr_b16 v[134:135], v201 offset:1952
    s_waitcnt lgkmcnt(10)
    v_mfma_f32_16x16x32_bf16 v[8:11], v[112:115], v[148:151], 0
    ds_read_b64_tr_b16 v[176:177], v201 offset:14496
    v_mfma_f32_16x16x32_bf16 v[8:11], v[156:159], v[192:195], v[8:11]
    buffer_load_dwordx4 v214, s[16:19], s86 offen offset:3072 lds
    ds_read_b64_tr_b16 v[178:179], v201 offset:16288
    v_mfma_f32_16x16x32_bf16 v[24:27], v[116:119], v[148:151], 0
    ds_read_b64_tr_b16 v[136:137], v202 offset:0
    v_mfma_f32_16x16x32_bf16 v[24:27], v[160:163], v[192:195], v[24:27]
    ds_read_b64_tr_b16 v[138:139], v202 offset:1792
    v_mfma_f32_16x16x32_bf16 v[40:43], v[120:123], v[148:151], 0
    s_add_u32 m0, s87, 94208
    s_nop 0
    buffer_load_dwordx4 v215, s[16:19], s86 offen offset:0 lds
    ds_read_b64_tr_b16 v[180:181], v202 offset:14336
    v_mfma_f32_16x16x32_bf16 v[40:43], v[164:167], v[192:195], v[40:43]
    ds_read_b64_tr_b16 v[182:183], v202 offset:16128
    v_mfma_f32_16x16x32_bf16 v[44:47], v[120:123], v[152:155], 0
    buffer_load_dwordx4 v216, s[16:19], s86 offen offset:1024 lds
    v_add_u32 v200, s46, v200
    v_mfma_f32_16x16x32_bf16 v[44:47], v[164:167], v[196:199], v[44:47]
    v_add_u32 v201, s46, v201
    v_mfma_f32_16x16x32_bf16 v[28:31], v[116:119], v[152:155], 0
    v_add_u32 v202, s46, v202
    v_mfma_f32_16x16x32_bf16 v[28:31], v[160:163], v[196:199], v[28:31]
    buffer_load_dwordx4 v217, s[16:19], s86 offen offset:2048 lds
    s_and_b32 s62, s62, 15
    s_lshl_b32 s63, s62, 7
    s_add_u32 s63, s63, s60
    s_mul_i32 s86, s62, 458752
    s_add_u32 s86, s86, s61
    s_add_u32 s62, s62, 1
    v_add_u32 v203, s46, v203
    v_mfma_f32_16x16x32_bf16 v[12:15], v[112:115], v[152:155], 0
    v_add_u32 v204, s46, v204
    v_mfma_f32_16x16x32_bf16 v[12:15], v[156:159], v[196:199], v[12:15]
    s_waitcnt vmcnt(12) lgkmcnt(0)
    s_mov_b32 s47, 13
g1loop_4:
    s_barrier
    v_mfma_f32_16x16x32_bf16 v[48:51], v[124:127], v[140:143], v[48:51]
    s_mov_b32 s91, s50
    s_add_u32 s50, s50, 45056
    s_cmp_eq_u32 s50, 135168
    s_cselect_b32 s46, 4294877184, s51
    s_cselect_b32 s50, 0, s50
    ds_read_b64_tr_b16 v[112:113], v200 offset:0
    v_mfma_f32_16x16x32_bf16 v[48:51], v[168:171], v[184:187], v[48:51]
    s_add_u32 m0, s88, s94
    ds_read_b64_tr_b16 v[114:115], v200 offset:1792
    v_mfma_f32_16x16x32_bf16 v[64:67], v[128:131], v[140:143], v[64:67]
    buffer_load_dwordx4 v207, s[8:11], s63 offen offset:0 lds
    ds_read_b64_tr_b16 v[156:157], v200 offset:14336
    v_mfma_f32_16x16x32_bf16 v[64:67], v[172:175], v[184:187], v[64:67]
    ds_read_b64_tr_b16 v[158:159], v200 offset:16128
    v_mfma_f32_16x16x32_bf16 v[80:83], v[132:135], v[140:143], v[80:83]
    ds_read_b64_tr_b16 v[116:117], v201 offset:32
    v_mfma_f32_16x16x32_bf16 v[80:83], v[176:179], v[184:187], v[80:83]
    ds_read_b64_tr_b16 v[118:119], v201 offset:1824
    v_mfma_f32_16x16x32_bf16 v[96:99], v[136:139], v[140:143], v[96:99]
    ds_read_b64_tr_b16 v[160:161], v201 offset:14368
    v_mfma_f32_16x16x32_bf16 v[96:99], v[180:183], v[184:187], v[96:99]
    buffer_load_dwordx4 v208, s[8:11], s63 offen offset:1024 lds
    ds_read_b64_tr_b16 v[162:163], v201 offset:16160
    v_mfma_f32_16x16x32_bf16 v[100:103], v[136:139], v[144:147], v[100:103]
    ds_read_b128 v[140:143], v203 offset:0
    v_mfma_f32_16x16x32_bf16 v[100:103], v[180:183], v[188:191], v[100:103]
    ds_read_b128 v[184:187], v204 offset:0
    v_mfma_f32_16x16x32_bf16 v[84:87], v[132:135], v[144:147], v[84:87]
    ds_read_b64_tr_b16 v[120:121], v200 offset:64
    v_mfma_f32_16x16x32_bf16 v[84:87], v[176:179], v[188:191], v[84:87]
    ds_read_b64_tr_b16 v[122:123], v200 offset:1856
    v_mfma_f32_16x16x32_bf16 v[68:71], v[128:131], v[144:147], v[68:71]
    buffer_load_dwordx4 v209, s[8:11], s63 offen offset:2048 lds
    ds_read_b64_tr_b16 v[164:165], v200 offset:14400
    v_mfma_f32_16x16x32_bf16 v[68:71], v[172:175], v[188:191], v[68:71]
    ds_read_b64_tr_b16 v[166:167], v200 offset:16192
    v_mfma_f32_16x16x32_bf16 v[52:55], v[124:127], v[144:147], v[52:55]
    v_mfma_f32_16x16x32_bf16 v[52:55], v[168:171], v[188:191], v[52:55]
    v_mfma_f32_16x16x32_bf16 v[56:59], v[124:127], v[148:151], v[56:59]
    ds_read_b128 v[144:147], v203 offset:2048
    v_mfma_f32_16x16x32_bf16 v[56:59], v[168:171], v[192:195], v[56:59]
    buffer_load_dwordx4 v210, s[8:11], s63 offen offset:3072 lds
    ds_read_b128 v[188:191], v204 offset:2048
    v_mfma_f32_16x16x32_bf16 v[72:75], v[128:131], v[148:151], v[72:75]
    v_mfma_f32_16x16x32_bf16 v[72:75], v[172:175], v[192:195], v[72:75]
    v_mfma_f32_16x16x32_bf16 v[88:91], v[132:135], v[148:151], v[88:91]
    v_mfma_f32_16x16x32_bf16 v[88:91], v[176:179], v[192:195], v[88:91]
    s_add_u32 m0, s88, s87
    v_mfma_f32_16x16x32_bf16 v[104:107], v[136:139], v[148:151], v[104:107]
    buffer_load_dwordx4 v211, s[16:19], s86 offen offset:0 lds
    v_mfma_f32_16x16x32_bf16 v[104:107], v[180:183], v[192:195], v[104:107]
    v_mfma_f32_16x16x32_bf16 v[108:111], v[136:139], v[152:155], v[108:111]
    ds_read_b128 v[148:151], v203 offset:4096
    v_mfma_f32_16x16x32_bf16 v[108:111], v[180:183], v[196:199], v[108:111]
    ds_read_b128 v[192:195], v204 offset:4096
    v_mfma_f32_16x16x32_bf16 v[92:95], v[132:135], v[152:155], v[92:95]
    v_mfma_f32_16x16x32_bf16 v[92:95], v[176:179], v[196:199], v[92:95]
    buffer_load_dwordx4 v212, s[16:19], s86 offen offset:1024 lds
    v_mfma_f32_16x16x32_bf16 v[76:79], v[128:131], v[152:155], v[76:79]
    v_mfma_f32_16x16x32_bf16 v[76:79], v[172:175], v[196:199], v[76:79]
    v_mfma_f32_16x16x32_bf16 v[60:63], v[124:127], v[152:155], v[60:63]
    v_mfma_f32_16x16x32_bf16 v[60:63], v[168:171], v[196:199], v[60:63]
    s_waitcnt lgkmcnt(4)
    v_mfma_f32_16x16x32_bf16 v[0:3], v[112:115], v[140:143], v[0:3]
    buffer_load_dwordx4 v213, s[16:19], s86 offen offset:2048 lds
    ds_read_b128 v[152:155], v203 offset:6144
    v_mfma_f32_16x16x32_bf16 v[0:3], v[156:159], v[184:187], v[0:3]
    ds_read_b128 v[196:199], v204 offset:6144
    v_mfma_f32_16x16x32_bf16 v[16:19], v[116:119], v[140:143], v[16:19]
    ds_read_b64_tr_b16 v[124:125], v201 offset:96
    v_mfma_f32_16x16x32_bf16 v[16:19], v[160:163], v[184:187], v[16:19]
    ds_read_b64_tr_b16 v[126:127], v201 offset:1888
    v_mfma_f32_16x16x32_bf16 v[32:35], v[120:123], v[140:143], v[32:35]
    ds_read_b64_tr_b16 v[168:169], v201 offset:14432
    v_mfma_f32_16x16x32_bf16 v[32:35], v[164:167], v[184:187], v[32:35]
    buffer_load_dwordx4 v214, s[16:19], s86 offen offset:3072 lds
    ds_read_b64_tr_b16 v[170:171], v201 offset:16224
    s_waitcnt lgkmcnt(8)
    v_mfma_f32_16x16x32_bf16 v[36:39], v[120:123], v[144:147], v[36:39]
    ds_read_b64_tr_b16 v[128:129], v200 offset:128
    v_mfma_f32_16x16x32_bf16 v[36:39], v[164:167], v[188:191], v[36:39]
    ds_read_b64_tr_b16 v[130:131], v200 offset:1920
    v_mfma_f32_16x16x32_bf16 v[20:23], v[116:119], v[144:147], v[20:23]
    ds_read_b64_tr_b16 v[172:173], v200 offset:14464
    v_mfma_f32_16x16x32_bf16 v[20:23], v[160:163], v[188:191], v[20:23]
    s_add_u32 m0, m0, 4096
    ds_read_b64_tr_b16 v[174:175], v200 offset:16256
    v_mfma_f32_16x16x32_bf16 v[4:7], v[112:115], v[144:147], v[4:7]
    buffer_load_dwordx4 v215, s[16:19], s86 offen offset:0 lds
    ds_read_b64_tr_b16 v[132:133], v201 offset:160
    v_mfma_f32_16x16x32_bf16 v[4:7], v[156:159], v[188:191], v[4:7]
    ds_read_b64_tr_b16 v[134:135], v201 offset:1952
    s_waitcnt lgkmcnt(10)
    v_mfma_f32_16x16x32_bf16 v[8:11], v[112:115], v[148:151], v[8:11]
    ds_read_b64_tr_b16 v[176:177], v201 offset:14496
    v_mfma_f32_16x16x32_bf16 v[8:11], v[156:159], v[192:195], v[8:11]
    ds_read_b64_tr_b16 v[178:179], v201 offset:16288
    v_mfma_f32_16x16x32_bf16 v[24:27], v[116:119], v[148:151], v[24:27]
    ds_read_b64_tr_b16 v[136:137], v202 offset:0
    v_mfma_f32_16x16x32_bf16 v[24:27], v[160:163], v[192:195], v[24:27]
    buffer_load_dwordx4 v216, s[16:19], s86 offen offset:1024 lds
    ds_read_b64_tr_b16 v[138:139], v202 offset:1792
    v_mfma_f32_16x16x32_bf16 v[40:43], v[120:123], v[148:151], v[40:43]
    ds_read_b64_tr_b16 v[180:181], v202 offset:14336
    v_mfma_f32_16x16x32_bf16 v[40:43], v[164:167], v[192:195], v[40:43]
    ds_read_b64_tr_b16 v[182:183], v202 offset:16128
    v_mfma_f32_16x16x32_bf16 v[44:47], v[120:123], v[152:155], v[44:47]
    v_add_u32 v200, s46, v200
    v_mfma_f32_16x16x32_bf16 v[44:47], v[164:167], v[196:199], v[44:47]
    v_add_u32 v201, s46, v201
    v_mfma_f32_16x16x32_bf16 v[28:31], v[116:119], v[152:155], v[28:31]
    buffer_load_dwordx4 v217, s[16:19], s86 offen offset:2048 lds
    s_and_b32 s62, s62, 15
    s_lshl_b32 s63, s62, 7
    s_add_u32 s63, s63, s60
    s_mul_i32 s86, s62, 458752
    s_add_u32 s86, s86, s61
    s_add_u32 s62, s62, 1
    s_mov_b32 s88, s91
    v_add_u32 v202, s46, v202
    v_mfma_f32_16x16x32_bf16 v[28:31], v[160:163], v[196:199], v[28:31]
    v_add_u32 v203, s46, v203
    v_mfma_f32_16x16x32_bf16 v[12:15], v[112:115], v[152:155], v[12:15]
    v_add_u32 v204, s46, v204
    s_sub_u32 s47, s47, 1
    s_cmp_lg_u32 s47, 0
    v_mfma_f32_16x16x32_bf16 v[12:15], v[156:159], v[196:199], v[12:15]
    s_waitcnt vmcnt(11) lgkmcnt(0)
    s_cbranch_scc1 g1loop_4
    s_barrier
    v_mfma_f32_16x16x32_bf16 v[48:51], v[124:127], v[140:143], v[48:51]
    s_mov_b32 s91, s50
    s_add_u32 s50, s50, 45056
    s_cmp_eq_u32 s50, 135168
    s_cselect_b32 s46, 4294877184, s51
    s_cselect_b32 s50, 0, s50
    ds_read_b64_tr_b16 v[112:113], v200 offset:0
    v_mfma_f32_16x16x32_bf16 v[48:51], v[168:171], v[184:187], v[48:51]
    s_mov_b32 s4, s84
    ds_read_b64_tr_b16 v[114:115], v200 offset:1792
    v_mfma_f32_16x16x32_bf16 v[64:67], v[128:131], v[140:143], v[64:67]
    s_mov_b32 s5, s85
    ds_read_b64_tr_b16 v[156:157], v200 offset:14336
    v_mfma_f32_16x16x32_bf16 v[64:67], v[172:175], v[184:187], v[64:67]
    s_mov_b32 s6, 268435456
    ds_read_b64_tr_b16 v[158:159], v200 offset:16128
    v_mfma_f32_16x16x32_bf16 v[80:83], v[132:135], v[140:143], v[80:83]
    s_mov_b32 s7, 0x20000
    ds_read_b64_tr_b16 v[116:117], v201 offset:32
    v_mfma_f32_16x16x32_bf16 v[80:83], v[176:179], v[184:187], v[80:83]
    ds_read_b64_tr_b16 v[118:119], v201 offset:1824
    v_mfma_f32_16x16x32_bf16 v[96:99], v[136:139], v[140:143], v[96:99]
    s_mov_b32 s12, s76
    ds_read_b64_tr_b16 v[160:161], v201 offset:14368
    v_mfma_f32_16x16x32_bf16 v[96:99], v[180:183], v[184:187], v[96:99]
    s_mov_b32 s13, s77
    ds_read_b64_tr_b16 v[162:163], v201 offset:16160
    v_mfma_f32_16x16x32_bf16 v[100:103], v[136:139], v[144:147], v[100:103]
    s_mov_b32 s14, 7340032
    ds_read_b128 v[140:143], v203 offset:0
    v_mfma_f32_16x16x32_bf16 v[100:103], v[180:183], v[188:191], v[100:103]
    s_mov_b32 s15, 0x20000
    ds_read_b128 v[184:187], v204 offset:0
    v_mfma_f32_16x16x32_bf16 v[84:87], v[132:135], v[144:147], v[84:87]
    ds_read_b64_tr_b16 v[120:121], v200 offset:64
    v_mfma_f32_16x16x32_bf16 v[84:87], v[176:179], v[188:191], v[84:87]
    s_lshl_b32 s94, s3, 12
    ds_read_b64_tr_b16 v[122:123], v200 offset:1856
    v_mfma_f32_16x16x32_bf16 v[68:71], v[128:131], v[144:147], v[68:71]
    s_lshl_b32 s56, s32, 1
    ds_read_b64_tr_b16 v[164:165], v200 offset:14400
    v_mfma_f32_16x16x32_bf16 v[68:71], v[172:175], v[188:191], v[68:71]
    s_add_u32 s56, s56, s34
    ds_read_b64_tr_b16 v[166:167], v200 offset:16192
    v_mfma_f32_16x16x32_bf16 v[52:55], v[124:127], v[144:147], v[52:55]
    s_mul_i32 s56, s56, 458752
    v_mfma_f32_16x16x32_bf16 v[52:55], v[168:171], v[188:191], v[52:55]
    v_mfma_f32_16x16x32_bf16 v[56:59], v[124:127], v[148:151], v[56:59]
    s_lshr_b32 s57, s3, 1
    ds_read_b128 v[144:147], v203 offset:2048
    v_mfma_f32_16x16x32_bf16 v[56:59], v[168:171], v[192:195], v[56:59]
    s_and_b32 s52, s3, 1
    ds_read_b128 v[188:191], v204 offset:2048
    v_mfma_f32_16x16x32_bf16 v[72:75], v[128:131], v[148:151], v[72:75]
    s_lshl_b32 s53, s52, 12
    v_mfma_f32_16x16x32_bf16 v[72:75], v[172:175], v[192:195], v[72:75]
    s_add_u32 s56, s56, s53
    v_mfma_f32_16x16x32_bf16 v[88:91], v[132:135], v[148:151], v[88:91]
    v_mfma_f32_16x16x32_bf16 v[88:91], v[176:179], v[192:195], v[88:91]
    s_mul_i32 s48, s57, 8192
    v_mfma_f32_16x16x32_bf16 v[104:107], v[136:139], v[148:151], v[104:107]
    s_add_u32 s48, s48, s56
    v_mfma_f32_16x16x32_bf16 v[104:107], v[180:183], v[192:195], v[104:107]
    s_mul_i32 s92, s57, 57344
    v_mfma_f32_16x16x32_bf16 v[108:111], v[136:139], v[152:155], v[108:111]
    s_add_u32 s92, s92, s56
    ds_read_b128 v[148:151], v203 offset:4096
    v_mfma_f32_16x16x32_bf16 v[108:111], v[180:183], v[196:199], v[108:111]
    ds_read_b128 v[192:195], v204 offset:4096
    v_mfma_f32_16x16x32_bf16 v[92:95], v[132:135], v[152:155], v[92:95]
    s_add_u32 s92, s92, 49152
    v_mfma_f32_16x16x32_bf16 v[92:95], v[176:179], v[196:199], v[92:95]
    s_mul_i32 s56, s34, 3670016
    v_mfma_f32_16x16x32_bf16 v[76:79], v[128:131], v[152:155], v[76:79]
    s_lshl_b32 s53, s33, 8
    v_mfma_f32_16x16x32_bf16 v[76:79], v[172:175], v[196:199], v[76:79]
    s_add_u32 s56, s56, s53
    v_mfma_f32_16x16x32_bf16 v[60:63], v[124:127], v[152:155], v[60:63]
    v_mfma_f32_16x16x32_bf16 v[60:63], v[168:171], v[196:199], v[60:63]
    s_lshl_b32 s49, s57, 18
    s_waitcnt lgkmcnt(4)
    v_mfma_f32_16x16x32_bf16 v[0:3], v[112:115], v[140:143], v[0:3]
    s_add_u32 s49, s49, s56
    ds_read_b128 v[152:155], v203 offset:6144
    v_mfma_f32_16x16x32_bf16 v[0:3], v[156:159], v[184:187], v[0:3]
    s_lshl_b32 s53, s52, 15
    ds_read_b128 v[196:199], v204 offset:6144
    v_mfma_f32_16x16x32_bf16 v[16:19], v[116:119], v[140:143], v[16:19]
    s_add_u32 s49, s49, s53
    ds_read_b64_tr_b16 v[124:125], v201 offset:96
    v_mfma_f32_16x16x32_bf16 v[16:19], v[160:163], v[184:187], v[16:19]
    ds_read_b64_tr_b16 v[126:127], v201 offset:1888
    v_mfma_f32_16x16x32_bf16 v[32:35], v[120:123], v[140:143], v[32:35]
    s_mul_i32 s93, s57, 458752
    ds_read_b64_tr_b16 v[168:169], v201 offset:14432
    v_mfma_f32_16x16x32_bf16 v[32:35], v[164:167], v[184:187], v[32:35]
    s_add_u32 s93, s93, s56
    ds_read_b64_tr_b16 v[170:171], v201 offset:16224
    s_waitcnt lgkmcnt(8)
    v_mfma_f32_16x16x32_bf16 v[36:39], v[120:123], v[144:147], v[36:39]
    s_lshl_b32 s53, s52, 14
    ds_read_b64_tr_b16 v[128:129], v200 offset:128
    v_mfma_f32_16x16x32_bf16 v[36:39], v[164:167], v[188:191], v[36:39]
    s_add_u32 s93, s93, s53
    ds_read_b64_tr_b16 v[130:131], v200 offset:1920
    v_mfma_f32_16x16x32_bf16 v[20:23], v[116:119], v[144:147], v[20:23]
    ds_read_b64_tr_b16 v[172:173], v200 offset:14464
    v_mfma_f32_16x16x32_bf16 v[20:23], v[160:163], v[188:191], v[20:23]
    s_add_u32 s93, s93, 196608
    ds_read_b64_tr_b16 v[174:175], v200 offset:16256
    v_mfma_f32_16x16x32_bf16 v[4:7], v[112:115], v[144:147], v[4:7]
    s_lshl_b32 s97, s32, 1
    ds_read_b64_tr_b16 v[132:133], v201 offset:160
    v_mfma_f32_16x16x32_bf16 v[4:7], v[156:159], v[188:191], v[4:7]
    s_add_u32 s97, s97, s34
    ds_read_b64_tr_b16 v[134:135], v201 offset:1952
    s_waitcnt lgkmcnt(10)
    v_mfma_f32_16x16x32_bf16 v[8:11], v[112:115], v[148:151], v[8:11]
    s_lshl_b32 s97, s97, 7
    ds_read_b64_tr_b16 v[176:177], v201 offset:14496
    v_mfma_f32_16x16x32_bf16 v[8:11], v[156:159], v[192:195], v[8:11]
    ds_read_b64_tr_b16 v[178:179], v201 offset:16288
    v_mfma_f32_16x16x32_bf16 v[24:27], v[116:119], v[148:151], v[24:27]
    s_add_u32 s97, s97, 42336256
    ds_read_b64_tr_b16 v[136:137], v202 offset:0
    v_mfma_f32_16x16x32_bf16 v[24:27], v[160:163], v[192:195], v[24:27]
    s_lshl_b32 s40, s33, 2
    ds_read_b64_tr_b16 v[138:139], v202 offset:1792
    v_mfma_f32_16x16x32_bf16 v[40:43], v[120:123], v[148:151], v[40:43]
    s_add_u32 s40, s40, s3
    ds_read_b64_tr_b16 v[180:181], v202 offset:14336
    v_mfma_f32_16x16x32_bf16 v[40:43], v[164:167], v[192:195], v[40:43]
    s_lshl_b32 s40, s40, 2
    ds_read_b64_tr_b16 v[182:183], v202 offset:16128
    v_mfma_f32_16x16x32_bf16 v[44:47], v[120:123], v[152:155], v[44:47]
    v_add_u32 v200, s46, v200
    v_mfma_f32_16x16x32_bf16 v[44:47], v[164:167], v[196:199], v[44:47]
    s_add_u32 s40, s40, s97
    v_add_u32 v201, s46, v201
    v_mfma_f32_16x16x32_bf16 v[28:31], v[116:119], v[152:155], v[28:31]
    s_lshl_b32 s41, s3, 8
    v_add_u32 v202, s46, v202
    v_mfma_f32_16x16x32_bf16 v[28:31], v[160:163], v[196:199], v[28:31]
    s_add_u32 s41, s41, s35
    v_add_u32 v203, s46, v203
    v_mfma_f32_16x16x32_bf16 v[12:15], v[112:115], v[152:155], v[12:15]
    v_add_u32 v204, s46, v204
    v_mfma_f32_16x16x32_bf16 v[12:15], v[156:159], v[196:199], v[12:15]
    s_waitcnt vmcnt(0) lgkmcnt(0)
    s_barrier
    v_mfma_f32_16x16x32_bf16 v[48:51], v[124:127], v[140:143], v[48:51]
    s_mov_b32 s91, s50
    s_add_u32 s50, s50, 45056
    s_cmp_eq_u32 s50, 135168
    s_cselect_b32 s46, 4294877184, s51
    s_cselect_b32 s50, 0, s50
    ds_read_b64_tr_b16 v[112:113], v200 offset:0
    v_mfma_f32_16x16x32_bf16 v[48:51], v[168:171], v[184:187], v[48:51]
    s_lshl_b32 s41, s41, 2
    ds_read_b64_tr_b16 v[114:115], v200 offset:1792
    v_mfma_f32_16x16x32_bf16 v[64:67], v[128:131], v[140:143], v[64:67]
    s_add_u32 s41, s41, 42602496
    ds_read_b64_tr_b16 v[156:157], v200 offset:14336
    v_mfma_f32_16x16x32_bf16 v[64:67], v[172:175], v[184:187], v[64:67]
    s_lshl_b32 s42, s37, 2
    ds_read_b64_tr_b16 v[158:159], v200 offset:16128
    v_mfma_f32_16x16x32_bf16 v[80:83], v[132:135], v[140:143], v[80:83]
    ds_read_b64_tr_b16 v[116:117], v201 offset:32
    v_mfma_f32_16x16x32_bf16 v[80:83], v[176:179], v[184:187], v[80:83]
    s_add_u32 s42, s42, 42467328
    ds_read_b64_tr_b16 v[118:119], v201 offset:1824
    v_mfma_f32_16x16x32_bf16 v[96:99], v[136:139], v[140:143], v[96:99]
    s_lshl_b32 s45, s32, 1
    ds_read_b64_tr_b16 v[160:161], v201 offset:14368
    v_mfma_f32_16x16x32_bf16 v[96:99], v[180:183], v[184:187], v[96:99]
    s_add_u32 s45, s45, s34
    ds_read_b64_tr_b16 v[162:163], v201 offset:16160
    v_mfma_f32_16x16x32_bf16 v[100:103], v[136:139], v[144:147], v[100:103]
    ds_read_b128 v[140:143], v203 offset:0
    v_mfma_f32_16x16x32_bf16 v[100:103], v[180:183], v[188:191], v[100:103]
    s_mul_i32 s45, s45, 458752
    ds_read_b128 v[184:187], v204 offset:0
    v_mfma_f32_16x16x32_bf16 v[84:87], v[132:135], v[144:147], v[84:87]
    s_mul_i32 s98, s33, 57344
    ds_read_b64_tr_b16 v[120:121], v200 offset:64
    v_mfma_f32_16x16x32_bf16 v[84:87], v[176:179], v[188:191], v[84:87]
    s_add_u32 s45, s45, s98
    ds_read_b64_tr_b16 v[122:123], v200 offset:1856
    v_mfma_f32_16x16x32_bf16 v[68:71], v[128:131], v[144:147], v[68:71]
    ds_read_b64_tr_b16 v[164:165], v200 offset:14400
    v_mfma_f32_16x16x32_bf16 v[68:71], v[172:175], v[188:191], v[68:71]
    s_lshl_b32 s98, s37, 11
    ds_read_b64_tr_b16 v[166:167], v200 offset:16192
    v_mfma_f32_16x16x32_bf16 v[52:55], v[124:127], v[144:147], v[52:55]
    s_add_u32 s99, s98, 2097152
    v_mfma_f32_16x16x32_bf16 v[52:55], v[168:171], v[188:191], v[52:55]
    s_bfe_u32 s100, s35, 0x20004
    v_mfma_f32_16x16x32_bf16 v[56:59], v[124:127], v[148:151], v[56:59]
    ds_read_b128 v[144:147], v203 offset:2048
    v_mfma_f32_16x16x32_bf16 v[56:59], v[168:171], v[192:195], v[56:59]
    s_lshl_b32 s100, s100, 2
    ds_read_b128 v[188:191], v204 offset:2048
    v_mfma_f32_16x16x32_bf16 v[72:75], v[128:131], v[148:151], v[72:75]
    s_add_u32 s100, s100, s3
    v_mfma_f32_16x16x32_bf16 v[72:75], v[172:175], v[192:195], v[72:75]
    s_lshl_b32 s100, s100, 8
    v_mfma_f32_16x16x32_bf16 v[88:91], v[132:135], v[148:151], v[88:91]
    v_mfma_f32_16x16x32_bf16 v[88:91], v[176:179], v[192:195], v[88:91]
    s_add_u32 s100, s100, 42602496
    v_mfma_f32_16x16x32_bf16 v[104:107], v[136:139], v[148:151], v[104:107]
    v_lshrrev_b32 v224, 4, v223
    v_mfma_f32_16x16x32_bf16 v[104:107], v[180:183], v[192:195], v[104:107]
    v_bfe_u32 v225, v223, 1, 3
    v_mfma_f32_16x16x32_bf16 v[108:111], v[136:139], v[152:155], v[108:111]
    ds_read_b128 v[148:151], v203 offset:4096
    v_mfma_f32_16x16x32_bf16 v[108:111], v[180:183], v[196:199], v[108:111]
    v_and_b32 v226, 1, v223
    ds_read_b128 v[192:195], v204 offset:4096
    v_mfma_f32_16x16x32_bf16 v[92:95], v[132:135], v[152:155], v[92:95]
    v_lshlrev_b32 v226, 4, v226
    v_mfma_f32_16x16x32_bf16 v[92:95], v[176:179], v[196:199], v[92:95]
    v_add_u32 v241, 0, v224
    v_mfma_f32_16x16x32_bf16 v[76:79], v[128:131], v[152:155], v[76:79]
    v_mfma_f32_16x16x32_bf16 v[76:79], v[172:175], v[196:199], v[76:79]
    v_and_b32 v227, 7, v241
    v_mfma_f32_16x16x32_bf16 v[60:63], v[124:127], v[152:155], v[60:63]
    v_xor_b32 v227, v227, v225
    v_mfma_f32_16x16x32_bf16 v[60:63], v[168:171], v[196:199], v[60:63]
    s_waitcnt lgkmcnt(6)
    v_mfma_f32_16x16x32_bf16 v[0:3], v[112:115], v[140:143], v[0:3]
    v_lshl_add_u32 v227, v227, 5, v226
    ds_read_b128 v[152:155], v203 offset:6144
    v_mfma_f32_16x16x32_bf16 v[16:19], v[116:119], v[140:143], v[16:19]
    v_lshl_add_u32 v241, v241, 11, v227
    ds_read_b128 v[196:199], v204 offset:6144
    v_mfma_f32_16x16x32_bf16 v[32:35], v[120:123], v[140:143], v[32:35]
    v_add_u32 v242, 4, v224
    ds_read_b64_tr_b16 v[124:125], v201 offset:96
    s_waitcnt lgkmcnt(4)
    v_mfma_f32_16x16x32_bf16 v[36:39], v[120:123], v[144:147], v[36:39]
    ds_read_b64_tr_b16 v[126:127], v201 offset:1888
    v_mfma_f32_16x16x32_bf16 v[20:23], v[116:119], v[144:147], v[20:23]
    v_and_b32 v227, 7, v242
    ds_read_b64_tr_b16 v[128:129], v200 offset:128
    v_mfma_f32_16x16x32_bf16 v[4:7], v[112:115], v[144:147], v[4:7]
    v_xor_b32 v227, v227, v225
    ds_read_b64_tr_b16 v[130:131], v200 offset:1920
    v_mfma_f32_16x16x32_bf16 v[8:11], v[112:115], v[148:151], v[8:11]
    v_lshl_add_u32 v227, v227, 5, v226
    ds_read_b64_tr_b16 v[132:133], v201 offset:160
    v_mfma_f32_16x16x32_bf16 v[24:27], v[116:119], v[148:151], v[24:27]
    ds_read_b64_tr_b16 v[134:135], v201 offset:1952
    v_mfma_f32_16x16x32_bf16 v[40:43], v[120:123], v[148:151], v[40:43]
    v_lshl_add_u32 v242, v242, 11, v227
    ds_read_b64_tr_b16 v[136:137], v202 offset:0
    s_waitcnt lgkmcnt(8)
    v_mfma_f32_16x16x32_bf16 v[44:47], v[120:123], v[152:155], v[44:47]
    v_subrev_u32 v242, 1024, v242
    ds_read_b64_tr_b16 v[138:139], v202 offset:1792
    v_mfma_f32_16x16x32_bf16 v[28:31], v[116:119], v[152:155], v[28:31]
    v_add_u32 v243, 8, v224
    ds_read_b64_tr_b16 v[168:169], v201 offset:14432
    v_mfma_f32_16x16x32_bf16 v[12:15], v[112:115], v[152:155], v[12:15]
    ds_read_b64_tr_b16 v[170:171], v201 offset:16224
    s_waitcnt lgkmcnt(6)
    v_mfma_f32_16x16x32_bf16 v[48:51], v[124:127], v[140:143], v[48:51]
    v_and_b32 v227, 7, v243
    ds_read_b64_tr_b16 v[172:173], v200 offset:14464
    v_mfma_f32_16x16x32_bf16 v[64:67], v[128:131], v[140:143], v[64:67]
    v_xor_b32 v227, v227, v225
    ds_read_b64_tr_b16 v[174:175], v200 offset:16256
    s_waitcnt lgkmcnt(4)
    v_mfma_f32_16x16x32_bf16 v[80:83], v[132:135], v[140:143], v[80:83]
    v_lshl_add_u32 v227, v227, 5, v226
    ds_read_b64_tr_b16 v[176:177], v201 offset:14496
    v_mfma_f32_16x16x32_bf16 v[96:99], v[136:139], v[140:143], v[96:99]
    ds_read_b64_tr_b16 v[178:179], v201 offset:16288
    v_mfma_f32_16x16x32_bf16 v[100:103], v[136:139], v[144:147], v[100:103]
    v_lshl_add_u32 v243, v243, 11, v227
    ds_read_b64_tr_b16 v[180:181], v202 offset:14336
    v_mfma_f32_16x16x32_bf16 v[84:87], v[132:135], v[144:147], v[84:87]
    v_subrev_u32 v243, 2048, v243
    ds_read_b64_tr_b16 v[182:183], v202 offset:16128
    v_mfma_f32_16x16x32_bf16 v[68:71], v[128:131], v[144:147], v[68:71]
    v_add_u32 v244, 12, v224
    v_add_u32 v200, s46, v200
    v_mfma_f32_16x16x32_bf16 v[52:55], v[124:127], v[144:147], v[52:55]
    v_add_u32 v201, s46, v201
    v_mfma_f32_16x16x32_bf16 v[56:59], v[124:127], v[148:151], v[56:59]
    v_and_b32 v227, 7, v244
    v_add_u32 v202, s46, v202
    v_mfma_f32_16x16x32_bf16 v[72:75], v[128:131], v[148:151], v[72:75]
    v_xor_b32 v227, v227, v225
    v_add_u32 v203, s46, v203
    v_mfma_f32_16x16x32_bf16 v[88:91], v[132:135], v[148:151], v[88:91]
    v_lshl_add_u32 v227, v227, 5, v226
    v_add_u32 v204, s46, v204
    v_mfma_f32_16x16x32_bf16 v[104:107], v[136:139], v[148:151], v[104:107]
    v_mfma_f32_16x16x32_bf16 v[108:111], v[136:139], v[152:155], v[108:111]
    v_lshl_add_u32 v244, v244, 11, v227
    v_mfma_f32_16x16x32_bf16 v[92:95], v[132:135], v[152:155], v[92:95]
    v_subrev_u32 v244, 3072, v244
    v_mfma_f32_16x16x32_bf16 v[76:79], v[128:131], v[152:155], v[76:79]
    v_mfma_f32_16x16x32_bf16 v[60:63], v[124:127], v[152:155], v[60:63]
    s_waitcnt vmcnt(0) lgkmcnt(0)
    s_barrier
    v_mfma_f32_16x16x32_bf16 v[0:3], v[156:159], v[184:187], v[0:3]
    v_and_b32 v150, 15, v223
    s_lshl_b32 s50, s44, 8
    s_add_u32 s50, s50, 162816
    v_lshl_add_u32 v153, v150, 2, s50
    v_mfma_f32_16x16x32_bf16 v[4:7], v[156:159], v[188:191], v[4:7]
    s_lshl_b32 s50, s43, 10
    s_add_u32 s50, s50, 160768
    v_lshl_add_u32 v151, v150, 3, s50
    s_lshl_b32 s50, s43, 7-zz0
    v_mfma_f32_16x16x32_bf16 v[8:11], v[156:159], v[192:195], v[8:11]
    s_add_u32 s50, s50, 161536
    v_lshl_add_u32 v152, v150, 3, s50
    ds_read_b32 v126, v153 offset:0
    ds_read_b32 v127, v153 offset:64
    v_mfma_f32_16x16x32_bf16 v[12:15], v[156:159], v[196:199], v[12:15]
    ds_read_b32 v128, v153 offset:128
    ds_read_b32 v129, v153 offset:192
    ds_read_b64 v[112:113], v151 offset:0
    ds_read_b64 v[114:115], v151 offset:128
    v_mfma_f32_16x16x32_bf16 v[28:31], v[160:163], v[196:199], v[28:31]
    ds_read_b64 v[116:117], v151 offset:256
    ds_read_b64 v[118:119], v151 offset:384
    ds_read_b64 v[120:121], v151 offset:512
    ds_read_b64 v[122:123], v151 offset:640
    v_mfma_f32_16x16x32_bf16 v[24:27], v[160:163], v[192:195], v[24:27]
    ds_read_b64 v[124:125], v152
    s_mov_b64 s[50:51], 0xffff
    s_mov_b32 s52, 0x01000100
    v_mfma_f32_16x16x32_bf16 v[20:23], v[160:163], v[188:191], v[20:23]
    v_mfma_f32_16x16x32_bf16 v[16:19], v[160:163], v[184:187], v[16:19]
    s_waitcnt lgkmcnt(7)
    v_and_b32 v202, 3, v223
    v_mfma_f32_16x16x32_bf16 v[32:35], v[164:167], v[184:187], v[32:35]
    s_lshl_b32 s53, s3, 2
    v_lshlrev_b32 v202, 2, v202
    v_mfma_f32_16x16x32_bf16 v[36:39], v[164:167], v[188:191], v[36:39]
    s_add_u32 s53, s53, 163328
    v_add_u32 v202, 163328, v202
    v_mfma_f32_16x16x32_bf16 v[40:43], v[164:167], v[192:195], v[40:43]
    v_mov_b32_e64 v201, s53
    v_cndmask_b32 v131, 0, v126, s[50:51]
    v_mfma_f32_16x16x32_bf16 v[44:47], v[164:167], v[196:199], v[44:47]
    v_and_b32 v216, 0xffff0000, v126
    v_cndmask_b32 v133, 0, v127, s[50:51]
    v_mfma_f32_16x16x32_bf16 v[60:63], v[168:171], v[196:199], v[60:63]
    v_and_b32 v218, 0xffff0000, v127
    v_cndmask_b32 v135, 0, v128, s[50:51]
    v_mfma_f32_16x16x32_bf16 v[56:59], v[168:171], v[192:195], v[56:59]
    v_and_b32 v146, 0xffff0000, v128
    v_cndmask_b32 v137, 0, v129, s[50:51]
    v_mfma_f32_16x16x32_bf16 v[52:55], v[168:171], v[188:191], v[52:55]
    v_and_b32 v148, 0xffff0000, v129
    v_perm_b32 v130, v131, v131, s52
    v_mfma_f32_16x16x32_bf16 v[48:51], v[168:171], v[184:187], v[48:51]
    v_rcp_f32 v138, v216
    v_perm_b32 v132, v133, v133, s52
    v_mfma_f32_16x16x32_bf16 v[64:67], v[172:175], v[184:187], v[64:67]
    v_rcp_f32 v140, v218
    v_perm_b32 v134, v135, v135, s52
    v_mfma_f32_16x16x32_bf16 v[68:71], v[172:175], v[188:191], v[68:71]
    v_rcp_f32 v142, v146
    v_perm_b32 v136, v137, v137, s52
    v_mfma_f32_16x16x32_bf16 v[72:75], v[172:175], v[192:195], v[72:75]
    v_rcp_f32 v144, v148
    v_mul_f32 v208, 0xc0135761, v138
    v_mfma_f32_16x16x32_bf16 v[76:79], v[172:175], v[196:199], v[76:79]
    v_mul_f32 v138, v138, v138
    v_mul_f32 v210, 0xc0135761, v140
    v_mfma_f32_16x16x32_bf16 v[92:95], v[176:179], v[196:199], v[92:95]
    v_mul_f32 v140, v140, v140
    v_mul_f32 v212, 0xc0135761, v142
    v_mfma_f32_16x16x32_bf16 v[88:91], v[176:179], v[192:195], v[88:91]
    v_mul_f32 v142, v142, v142
    v_mul_f32 v214, 0xc0135761, v144
    v_mfma_f32_16x16x32_bf16 v[84:87], v[176:179], v[188:191], v[84:87]
    v_mul_f32 v144, v144, v144
    v_mul_f32 v138, 0x3d372713, v138
    v_mfma_f32_16x16x32_bf16 v[80:83], v[176:179], v[184:187], v[80:83]
    v_mov_b32 v209, v208
    v_mul_f32 v140, 0x3d372713, v140
    v_mfma_f32_16x16x32_bf16 v[96:99], v[180:183], v[184:187], v[96:99]
    v_mov_b32 v211, v210
    v_mul_f32 v142, 0x3d372713, v142
    v_mfma_f32_16x16x32_bf16 v[100:103], v[180:183], v[188:191], v[100:103]
    v_mov_b32 v213, v212
    v_mul_f32 v144, 0x3d372713, v144
    v_mfma_f32_16x16x32_bf16 v[104:107], v[180:183], v[192:195], v[104:107]
    v_mov_b32 v215, v214
    v_mul_f32 v138, v138, v208
    v_mfma_f32_16x16x32_bf16 v[108:111], v[180:183], v[196:199], v[108:111]
    v_mov_b32 v217, v216
    v_mul_f32 v140, v140, v210
    v_mov_b32 v219, v218
    v_mul_f32 v142, v142, v212
    v_mov_b32 v147, v146
    v_mul_f32 v144, v144, v214
    v_mov_b32 v149, v148
    v_mov_b32 v139, v138
    v_mov_b32 v141, v140
    v_mov_b32 v143, v142
    v_mov_b32 v145, v144
    s_waitcnt lgkmcnt(0)
    v_mfma_f32_16x16x16_bf16 v[0:3], v[112:113], v[130:131], v[0:3]
    v_mfma_f32_16x16x16_bf16 v[16:19], v[114:115], v[130:131], v[16:19]
    v_mfma_f32_16x16x16_bf16 v[4:7], v[112:113], v[132:133], v[4:7]
    v_mfma_f32_16x16x16_bf16 v[20:23], v[114:115], v[132:133], v[20:23]
    v_mfma_f32_16x16x16_bf16 v[8:11], v[112:113], v[134:135], v[8:11]
    v_mfma_f32_16x16x16_bf16 v[24:27], v[114:115], v[134:135], v[24:27]
    v_mfma_f32_16x16x16_bf16 v[12:15], v[112:113], v[136:137], v[12:15]
    v_mfma_f32_16x16x16_bf16 v[28:31], v[114:115], v[136:137], v[28:31]
    s_add_u32 s39, s45, 49152
    s_mul_i32 s46, s43, 0
    s_add_u32 s45, s45, s46
    s_add_u32 s46, s45, 16384
    s_add_u32 s47, s45, 32768
    s_add_u32 s50, s94, 65536
    v_add_u32 v200, s50, v240
    v_pk_mul_f32 v[160:161], v[0:1], v[0:1]
    v_pk_mul_f32 v[162:163], v[2:3], v[2:3]
    v_pk_mul_f32 v[164:165], v[16:17], v[16:17]
    v_pk_mul_f32 v[166:167], v[18:19], v[18:19]
    v_pk_mul_f32 v[168:169], v[4:5], v[4:5]
    v_pk_mul_f32 v[170:171], v[6:7], v[6:7]
    v_pk_mul_f32 v[172:173], v[20:21], v[20:21]
    v_pk_mul_f32 v[174:175], v[22:23], v[22:23]
    v_pk_fma_f32 v[160:161], v[160:161], v[138:139], v[208:209]
    v_pk_fma_f32 v[162:163], v[162:163], v[138:139], v[208:209]
    v_pk_fma_f32 v[164:165], v[164:165], v[138:139], v[208:209]
    v_pk_fma_f32 v[166:167], v[166:167], v[138:139], v[208:209]
    v_pk_fma_f32 v[168:169], v[168:169], v[140:141], v[210:211]
    v_pk_fma_f32 v[170:171], v[170:171], v[140:141], v[210:211]
    v_pk_fma_f32 v[172:173], v[172:173], v[140:141], v[210:211]
    v_pk_fma_f32 v[174:175], v[174:175], v[140:141], v[210:211]
    v_pk_mul_f32 v[160:161], v[160:161], v[0:1]
    v_pk_mul_f32 v[162:163], v[162:163], v[2:3]
    v_pk_mul_f32 v[164:165], v[164:165], v[16:17]
    v_pk_mul_f32 v[166:167], v[166:167], v[18:19]
    v_pk_mul_f32 v[168:169], v[168:169], v[4:5]
    v_pk_mul_f32 v[170:171], v[170:171], v[6:7]
    v_pk_mul_f32 v[172:173], v[172:173], v[20:21]
    v_pk_mul_f32 v[174:175], v[174:175], v[22:23]
    v_exp_f32 v160, v160
    v_mfma_f32_16x16x16_bf16 v[32:35], v[116:117], v[130:131], v[32:35]
    v_exp_f32 v161, v161
    v_exp_f32 v162, v162
    v_mfma_f32_16x16x16_bf16 v[36:39], v[116:117], v[132:133], v[36:39]
    v_exp_f32 v163, v163
    v_exp_f32 v164, v164
    v_mfma_f32_16x16x16_bf16 v[40:43], v[116:117], v[134:135], v[40:43]
    v_exp_f32 v165, v165
    v_exp_f32 v166, v166
    v_mfma_f32_16x16x16_bf16 v[44:47], v[116:117], v[136:137], v[44:47]
    v_exp_f32 v167, v167
    v_exp_f32 v168, v168
    v_mfma_f32_16x16x16_bf16 v[60:63], v[118:119], v[136:137], v[60:63]
    v_exp_f32 v169, v169
    v_exp_f32 v170, v170
    v_mfma_f32_16x16x16_bf16 v[56:59], v[118:119], v[134:135], v[56:59]
    v_exp_f32 v171, v171
    v_exp_f32 v172, v172
    v_mfma_f32_16x16x16_bf16 v[52:55], v[118:119], v[132:133], v[52:55]
    v_exp_f32 v173, v173
    v_exp_f32 v174, v174
    v_mfma_f32_16x16x16_bf16 v[48:51], v[118:119], v[130:131], v[48:51]
    v_exp_f32 v175, v175
    v_pk_fma_f32 v[160:161], v[160:161], v[216:217], v[216:217]
    v_mfma_f32_16x16x16_bf16 v[64:67], v[120:121], v[130:131], v[64:67]
    v_pk_fma_f32 v[162:163], v[162:163], v[216:217], v[216:217]
    v_pk_fma_f32 v[164:165], v[164:165], v[216:217], v[216:217]
    v_mfma_f32_16x16x16_bf16 v[68:71], v[120:121], v[132:133], v[68:71]
    v_pk_fma_f32 v[166:167], v[166:167], v[216:217], v[216:217]
    v_pk_fma_f32 v[168:169], v[168:169], v[218:219], v[218:219]
    v_mfma_f32_16x16x16_bf16 v[72:75], v[120:121], v[134:135], v[72:75]
    v_pk_fma_f32 v[170:171], v[170:171], v[218:219], v[218:219]
    v_pk_fma_f32 v[172:173], v[172:173], v[218:219], v[218:219]
    v_mfma_f32_16x16x16_bf16 v[76:79], v[120:121], v[136:137], v[76:79]
    v_pk_fma_f32 v[174:175], v[174:175], v[218:219], v[218:219]
    v_rcp_f32 v160, v160
    v_mfma_f32_16x16x16_bf16 v[92:95], v[122:123], v[136:137], v[92:95]
    v_rcp_f32 v161, v161
    v_rcp_f32 v162, v162
    v_mfma_f32_16x16x16_bf16 v[88:91], v[122:123], v[134:135], v[88:91]
    v_rcp_f32 v163, v163
    v_rcp_f32 v164, v164
    v_mfma_f32_16x16x16_bf16 v[84:87], v[122:123], v[132:133], v[84:87]
    v_rcp_f32 v165, v165
    v_rcp_f32 v166, v166
    v_mfma_f32_16x16x16_bf16 v[80:83], v[122:123], v[130:131], v[80:83]
    v_rcp_f32 v167, v167
    v_rcp_f32 v168, v168
    v_mfma_f32_16x16x16_bf16 v[96:99], v[124:125], v[130:131], v[96:99]
    v_rcp_f32 v169, v169
    v_rcp_f32 v170, v170
    v_mfma_f32_16x16x16_bf16 v[100:103], v[124:125], v[132:133], v[100:103]
    v_rcp_f32 v171, v171
    v_rcp_f32 v172, v172
    v_mfma_f32_16x16x16_bf16 v[104:107], v[124:125], v[134:135], v[104:107]
    v_rcp_f32 v173, v173
    v_rcp_f32 v174, v174
    v_mfma_f32_16x16x16_bf16 v[108:111], v[124:125], v[136:137], v[108:111]
    v_rcp_f32 v175, v175
    v_pk_mul_f32 v[160:161], v[160:161], v[0:1]
    v_pk_mul_f32 v[162:163], v[162:163], v[2:3]
    v_pk_mul_f32 v[164:165], v[164:165], v[16:17]
    v_pk_mul_f32 v[166:167], v[166:167], v[18:19]
    v_pk_mul_f32 v[168:169], v[168:169], v[4:5]
    v_pk_mul_f32 v[170:171], v[170:171], v[6:7]
    v_pk_mul_f32 v[172:173], v[172:173], v[20:21]
    v_pk_mul_f32 v[174:175], v[174:175], v[22:23]
    v_cvt_pk_bf16_f32 v192, v160, v161
    v_cvt_pk_bf16_f32 v193, v162, v163
    v_cvt_pk_bf16_f32 v194, v164, v165
    v_cvt_pk_bf16_f32 v195, v166, v167
    v_cvt_pk_bf16_f32 v196, v168, v169
    v_cvt_pk_bf16_f32 v197, v170, v171
    v_cvt_pk_bf16_f32 v198, v172, v173
    v_cvt_pk_bf16_f32 v199, v174, v175
    buffer_store_dwordx4 v[192:195], v205, s[4:7], s45 offen offset:0 sc1
    ds_write_b128 v205, v[192:195] offset:0
    buffer_store_dwordx4 v[196:199], v205, s[4:7], s45 offen offset:1024 sc1
    ds_write_b128 v205, v[196:199] offset:1024
    v_pk_mul_f32 v[176:177], v[8:9], v[8:9]
    v_pk_mul_f32 v[178:179], v[10:11], v[10:11]
    v_pk_mul_f32 v[180:181], v[24:25], v[24:25]
    v_pk_mul_f32 v[182:183], v[26:27], v[26:27]
    v_pk_mul_f32 v[184:185], v[12:13], v[12:13]
    v_pk_mul_f32 v[186:187], v[14:15], v[14:15]
    v_pk_mul_f32 v[188:189], v[28:29], v[28:29]
    v_pk_mul_f32 v[190:191], v[30:31], v[30:31]
    v_pk_fma_f32 v[176:177], v[176:177], v[142:143], v[212:213]
    v_pk_fma_f32 v[178:179], v[178:179], v[142:143], v[212:213]
    v_pk_fma_f32 v[180:181], v[180:181], v[142:143], v[212:213]
    v_pk_fma_f32 v[182:183], v[182:183], v[142:143], v[212:213]
    v_pk_fma_f32 v[184:185], v[184:185], v[144:145], v[214:215]
    v_pk_fma_f32 v[186:187], v[186:187], v[144:145], v[214:215]
    v_pk_fma_f32 v[188:189], v[188:189], v[144:145], v[214:215]
    v_pk_fma_f32 v[190:191], v[190:191], v[144:145], v[214:215]
    v_pk_mul_f32 v[176:177], v[176:177], v[8:9]
    v_pk_mul_f32 v[178:179], v[178:179], v[10:11]
    v_pk_mul_f32 v[180:181], v[180:181], v[24:25]
    v_pk_mul_f32 v[182:183], v[182:183], v[26:27]
    v_pk_mul_f32 v[184:185], v[184:185], v[12:13]
    v_pk_mul_f32 v[186:187], v[186:187], v[14:15]
    v_pk_mul_f32 v[188:189], v[188:189], v[28:29]
    v_pk_mul_f32 v[190:191], v[190:191], v[30:31]
    v_exp_f32 v176, v176
    v_exp_f32 v177, v177
    v_exp_f32 v178, v178
    v_exp_f32 v179, v179
    v_exp_f32 v180, v180
    v_exp_f32 v181, v181
    v_exp_f32 v182, v182
    v_exp_f32 v183, v183
    v_exp_f32 v184, v184
    v_exp_f32 v185, v185
    v_exp_f32 v186, v186
    v_exp_f32 v187, v187
    v_exp_f32 v188, v188
    v_exp_f32 v189, v189
    v_exp_f32 v190, v190
    v_exp_f32 v191, v191
    v_pk_fma_f32 v[176:177], v[176:177], v[146:147], v[146:147]
    v_pk_fma_f32 v[178:179], v[178:179], v[146:147], v[146:147]
    v_pk_fma_f32 v[180:181], v[180:181], v[146:147], v[146:147]
    v_pk_fma_f32 v[182:183], v[182:183], v[146:147], v[146:147]
    v_pk_fma_f32 v[184:185], v[184:185], v[148:149], v[148:149]
    v_pk_fma_f32 v[186:187], v[186:187], v[148:149], v[148:149]
    v_pk_fma_f32 v[188:189], v[188:189], v[148:149], v[148:149]
    v_pk_fma_f32 v[190:191], v[190:191], v[148:149], v[148:149]
    v_rcp_f32 v176, v176
    v_rcp_f32 v177, v177
    v_rcp_f32 v178, v178
    v_rcp_f32 v179, v179
    v_rcp_f32 v180, v180
    v_rcp_f32 v181, v181
    v_rcp_f32 v182, v182
    v_rcp_f32 v183, v183
    v_rcp_f32 v184, v184
    v_rcp_f32 v185, v185
    v_rcp_f32 v186, v186
    v_rcp_f32 v187, v187
    v_rcp_f32 v188, v188
    v_rcp_f32 v189, v189
    v_rcp_f32 v190, v190
    v_rcp_f32 v191, v191
    v_pk_mul_f32 v[176:177], v[176:177], v[8:9]
    v_pk_mul_f32 v[178:179], v[178:179], v[10:11]
    v_pk_mul_f32 v[180:181], v[180:181], v[24:25]
    v_pk_mul_f32 v[182:183], v[182:183], v[26:27]
    v_pk_mul_f32 v[184:185], v[184:185], v[12:13]
    v_pk_mul_f32 v[186:187], v[186:187], v[14:15]
    v_pk_mul_f32 v[188:189], v[188:189], v[28:29]
    v_pk_mul_f32 v[190:191], v[190:191], v[30:31]
    v_cvt_pk_bf16_f32 v150, v176, v177
    v_cvt_pk_bf16_f32 v151, v178, v179
    v_cvt_pk_bf16_f32 v152, v180, v181
    v_cvt_pk_bf16_f32 v153, v182, v183
    v_cvt_pk_bf16_f32 v154, v184, v185
    v_cvt_pk_bf16_f32 v155, v186, v187
    v_cvt_pk_bf16_f32 v156, v188, v189
    v_cvt_pk_bf16_f32 v157, v190, v191
    buffer_store_dwordx4 v[150:153], v205, s[4:7], s45 offen offset:2048 sc1
    ds_write_b128 v205, v[150:153] offset:2048
    buffer_store_dwordx4 v[154:157], v205, s[4:7], s45 offen offset:3072 sc1
    ds_write_b128 v205, v[154:157] offset:3072
    v_pk_mul_f32 v[160:161], v[32:33], v[32:33]
    v_pk_mul_f32 v[162:163], v[34:35], v[34:35]
    v_pk_mul_f32 v[164:165], v[48:49], v[48:49]
    v_pk_mul_f32 v[166:167], v[50:51], v[50:51]
    v_pk_mul_f32 v[168:169], v[36:37], v[36:37]
    v_pk_mul_f32 v[170:171], v[38:39], v[38:39]
    v_pk_mul_f32 v[172:173], v[52:53], v[52:53]
    v_pk_mul_f32 v[174:175], v[54:55], v[54:55]
    s_waitcnt lgkmcnt(0)
    v_mov_b32 v255, 1
    s_mov_b64 exec, 1
    ds_write_b32 v201, v255 offset:16
    s_mov_b64 exec, -1
    v_pk_fma_f32 v[160:161], v[160:161], v[138:139], v[208:209]
    v_pk_fma_f32 v[162:163], v[162:163], v[138:139], v[208:209]
    v_pk_fma_f32 v[164:165], v[164:165], v[138:139], v[208:209]
    v_pk_fma_f32 v[166:167], v[166:167], v[138:139], v[208:209]
    v_pk_fma_f32 v[168:169], v[168:169], v[140:141], v[210:211]
    v_pk_fma_f32 v[170:171], v[170:171], v[140:141], v[210:211]
    v_pk_fma_f32 v[172:173], v[172:173], v[140:141], v[210:211]
    v_pk_fma_f32 v[174:175], v[174:175], v[140:141], v[210:211]
    v_pk_mul_f32 v[160:161], v[160:161], v[32:33]
    v_pk_mul_f32 v[162:163], v[162:163], v[34:35]
    v_pk_mul_f32 v[164:165], v[164:165], v[48:49]
    v_pk_mul_f32 v[166:167], v[166:167], v[50:51]
    v_pk_mul_f32 v[168:169], v[168:169], v[36:37]
    v_pk_mul_f32 v[170:171], v[170:171], v[38:39]
    v_pk_mul_f32 v[172:173], v[172:173], v[52:53]
    v_pk_mul_f32 v[174:175], v[174:175], v[54:55]
    v_exp_f32 v160, v160
    v_exp_f32 v161, v161
    v_exp_f32 v162, v162
    v_exp_f32 v163, v163
    v_exp_f32 v164, v164
    v_exp_f32 v165, v165
    v_exp_f32 v166, v166
    v_exp_f32 v167, v167
    v_exp_f32 v168, v168
    v_exp_f32 v169, v169
    v_exp_f32 v170, v170
    v_exp_f32 v171, v171
    v_exp_f32 v172, v172
    v_exp_f32 v173, v173
    v_exp_f32 v174, v174
    v_exp_f32 v175, v175
    v_pk_fma_f32 v[160:161], v[160:161], v[216:217], v[216:217]
    v_pk_fma_f32 v[162:163], v[162:163], v[216:217], v[216:217]
    v_pk_fma_f32 v[164:165], v[164:165], v[216:217], v[216:217]
    v_pk_fma_f32 v[166:167], v[166:167], v[216:217], v[216:217]
    v_pk_fma_f32 v[168:169], v[168:169], v[218:219], v[218:219]
    v_pk_fma_f32 v[170:171], v[170:171], v[218:219], v[218:219]
    v_pk_fma_f32 v[172:173], v[172:173], v[218:219], v[218:219]
    v_pk_fma_f32 v[174:175], v[174:175], v[218:219], v[218:219]
    v_rcp_f32 v160, v160
    v_rcp_f32 v161, v161
    v_rcp_f32 v162, v162
    v_rcp_f32 v163, v163
    v_rcp_f32 v164, v164
    v_rcp_f32 v165, v165
    v_rcp_f32 v166, v166
    v_rcp_f32 v167, v167
    v_rcp_f32 v168, v168
    v_rcp_f32 v169, v169
    v_rcp_f32 v170, v170
    v_rcp_f32 v171, v171
    v_rcp_f32 v172, v172
    v_rcp_f32 v173, v173
    v_rcp_f32 v174, v174
    v_rcp_f32 v175, v175
    v_pk_mul_f32 v[160:161], v[160:161], v[32:33]
    v_pk_mul_f32 v[162:163], v[162:163], v[34:35]
    v_pk_mul_f32 v[164:165], v[164:165], v[48:49]
    v_pk_mul_f32 v[166:167], v[166:167], v[50:51]
    v_pk_mul_f32 v[168:169], v[168:169], v[36:37]
    v_pk_mul_f32 v[170:171], v[170:171], v[38:39]
    v_pk_mul_f32 v[172:173], v[172:173], v[52:53]
    v_pk_mul_f32 v[174:175], v[174:175], v[54:55]
    v_cvt_pk_bf16_f32 v112, v160, v161
    v_cvt_pk_bf16_f32 v113, v162, v163
    v_cvt_pk_bf16_f32 v114, v164, v165
    v_cvt_pk_bf16_f32 v115, v166, v167
    v_cvt_pk_bf16_f32 v116, v168, v169
    v_cvt_pk_bf16_f32 v117, v170, v171
    v_cvt_pk_bf16_f32 v118, v172, v173
    v_cvt_pk_bf16_f32 v119, v174, v175
    ds_write_b128 v205, v[112:115] offset:16384
    ds_write_b128 v205, v[116:119] offset:17408
    v_pk_mul_f32 v[176:177], v[40:41], v[40:41]
    v_pk_mul_f32 v[178:179], v[42:43], v[42:43]
    v_pk_mul_f32 v[180:181], v[56:57], v[56:57]
    v_pk_mul_f32 v[182:183], v[58:59], v[58:59]
    v_pk_mul_f32 v[184:185], v[44:45], v[44:45]
    v_pk_mul_f32 v[186:187], v[46:47], v[46:47]
    v_pk_mul_f32 v[188:189], v[60:61], v[60:61]
    v_pk_mul_f32 v[190:191], v[62:63], v[62:63]
    v_pk_fma_f32 v[176:177], v[176:177], v[142:143], v[212:213]
    v_pk_fma_f32 v[178:179], v[178:179], v[142:143], v[212:213]
    v_pk_fma_f32 v[180:181], v[180:181], v[142:143], v[212:213]
    v_pk_fma_f32 v[182:183], v[182:183], v[142:143], v[212:213]
    v_pk_fma_f32 v[184:185], v[184:185], v[144:145], v[214:215]
    v_pk_fma_f32 v[186:187], v[186:187], v[144:145], v[214:215]
    v_pk_fma_f32 v[188:189], v[188:189], v[144:145], v[214:215]
    v_pk_fma_f32 v[190:191], v[190:191], v[144:145], v[214:215]
    v_pk_mul_f32 v[176:177], v[176:177], v[40:41]
    v_pk_mul_f32 v[178:179], v[178:179], v[42:43]
    v_pk_mul_f32 v[180:181], v[180:181], v[56:57]
    v_pk_mul_f32 v[182:183], v[182:183], v[58:59]
    v_pk_mul_f32 v[184:185], v[184:185], v[44:45]
    v_pk_mul_f32 v[186:187], v[186:187], v[46:47]
    v_pk_mul_f32 v[188:189], v[188:189], v[60:61]
    v_pk_mul_f32 v[190:191], v[190:191], v[62:63]
    v_exp_f32 v176, v176
    v_exp_f32 v177, v177
    v_exp_f32 v178, v178
    v_exp_f32 v179, v179
    v_exp_f32 v180, v180
    v_exp_f32 v181, v181
    v_exp_f32 v182, v182
    v_exp_f32 v183, v183
    v_exp_f32 v184, v184
    v_exp_f32 v185, v185
    v_exp_f32 v186, v186
    v_exp_f32 v187, v187
    v_exp_f32 v188, v188
    v_exp_f32 v189, v189
    v_exp_f32 v190, v190
    v_exp_f32 v191, v191
    v_pk_fma_f32 v[176:177], v[176:177], v[146:147], v[146:147]
    v_pk_fma_f32 v[178:179], v[178:179], v[146:147], v[146:147]
    v_pk_fma_f32 v[180:181], v[180:181], v[146:147], v[146:147]
    v_pk_fma_f32 v[182:183], v[182:183], v[146:147], v[146:147]
    v_pk_fma_f32 v[184:185], v[184:185], v[148:149], v[148:149]
    v_pk_fma_f32 v[186:187], v[186:187], v[148:149], v[148:149]
    v_pk_fma_f32 v[188:189], v[188:189], v[148:149], v[148:149]
    v_pk_fma_f32 v[190:191], v[190:191], v[148:149], v[148:149]
    v_rcp_f32 v176, v176
    v_rcp_f32 v177, v177
    v_rcp_f32 v178, v178
    v_rcp_f32 v179, v179
    v_rcp_f32 v180, v180
    v_rcp_f32 v181, v181
    v_rcp_f32 v182, v182
    v_rcp_f32 v183, v183
    v_rcp_f32 v184, v184
    v_rcp_f32 v185, v185
    v_rcp_f32 v186, v186
    v_rcp_f32 v187, v187
    v_rcp_f32 v188, v188
    v_rcp_f32 v189, v189
    v_rcp_f32 v190, v190
    v_rcp_f32 v191, v191
    v_pk_mul_f32 v[176:177], v[176:177], v[40:41]
    v_pk_mul_f32 v[178:179], v[178:179], v[42:43]
    v_pk_mul_f32 v[180:181], v[180:181], v[56:57]
    v_pk_mul_f32 v[182:183], v[182:183], v[58:59]
    v_pk_mul_f32 v[184:185], v[184:185], v[44:45]
    v_pk_mul_f32 v[186:187], v[186:187], v[46:47]
    v_pk_mul_f32 v[188:189], v[188:189], v[60:61]
    v_pk_mul_f32 v[190:191], v[190:191], v[62:63]
    v_cvt_pk_bf16_f32 v120, v176, v177
    v_cvt_pk_bf16_f32 v121, v178, v179
    v_cvt_pk_bf16_f32 v122, v180, v181
    v_cvt_pk_bf16_f32 v123, v182, v183
    v_cvt_pk_bf16_f32 v124, v184, v185
    v_cvt_pk_bf16_f32 v125, v186, v187
    v_cvt_pk_bf16_f32 v126, v188, v189
    v_cvt_pk_bf16_f32 v127, v190, v191
    ds_write_b128 v205, v[120:123] offset:18432
    ds_write_b128 v205, v[124:127] offset:19456
    s_waitcnt vmcnt(0)
    s_mov_b64 exec, 1
    v_mov_b32 v255, 1
    buffer_store_dword v255, off, s[4:7], s40 sc1
    s_mov_b64 exec, -1
    v_pk_mul_f32 v[160:161], v[64:65], v[64:65]
    v_pk_mul_f32 v[162:163], v[66:67], v[66:67]
    v_pk_mul_f32 v[164:165], v[80:81], v[80:81]
    v_pk_mul_f32 v[166:167], v[82:83], v[82:83]
    v_pk_mul_f32 v[168:169], v[68:69], v[68:69]
    v_pk_mul_f32 v[170:171], v[70:71], v[70:71]
    v_pk_mul_f32 v[172:173], v[84:85], v[84:85]
    v_pk_mul_f32 v[174:175], v[86:87], v[86:87]
    s_waitcnt lgkmcnt(0)
    v_mov_b32 v255, 2
    s_mov_b64 exec, 1
    ds_write_b32 v201, v255 offset:16
    s_mov_b64 exec, -1
    v_pk_fma_f32 v[160:161], v[160:161], v[138:139], v[208:209]
    v_pk_fma_f32 v[162:163], v[162:163], v[138:139], v[208:209]
    v_pk_fma_f32 v[164:165], v[164:165], v[138:139], v[208:209]
    v_pk_fma_f32 v[166:167], v[166:167], v[138:139], v[208:209]
    v_pk_fma_f32 v[168:169], v[168:169], v[140:141], v[210:211]
    v_pk_fma_f32 v[170:171], v[170:171], v[140:141], v[210:211]
    v_pk_fma_f32 v[172:173], v[172:173], v[140:141], v[210:211]
    v_pk_fma_f32 v[174:175], v[174:175], v[140:141], v[210:211]
    v_pk_mul_f32 v[160:161], v[160:161], v[64:65]
    v_pk_mul_f32 v[162:163], v[162:163], v[66:67]
    v_pk_mul_f32 v[164:165], v[164:165], v[80:81]
    v_pk_mul_f32 v[166:167], v[166:167], v[82:83]
    v_pk_mul_f32 v[168:169], v[168:169], v[68:69]
    v_pk_mul_f32 v[170:171], v[170:171], v[70:71]
    v_pk_mul_f32 v[172:173], v[172:173], v[84:85]
    v_pk_mul_f32 v[174:175], v[174:175], v[86:87]
    v_exp_f32 v160, v160
    v_exp_f32 v161, v161
    v_exp_f32 v162, v162
    v_exp_f32 v163, v163
    v_exp_f32 v164, v164
    v_exp_f32 v165, v165
    v_exp_f32 v166, v166
    v_exp_f32 v167, v167
    v_exp_f32 v168, v168
    v_exp_f32 v169, v169
    v_exp_f32 v170, v170
    v_exp_f32 v171, v171
    v_exp_f32 v172, v172
    v_exp_f32 v173, v173
    v_exp_f32 v174, v174
    v_exp_f32 v175, v175
    v_pk_fma_f32 v[160:161], v[160:161], v[216:217], v[216:217]
    v_pk_fma_f32 v[162:163], v[162:163], v[216:217], v[216:217]
    v_pk_fma_f32 v[164:165], v[164:165], v[216:217], v[216:217]
    v_pk_fma_f32 v[166:167], v[166:167], v[216:217], v[216:217]
    v_pk_fma_f32 v[168:169], v[168:169], v[218:219], v[218:219]
    v_pk_fma_f32 v[170:171], v[170:171], v[218:219], v[218:219]
    v_pk_fma_f32 v[172:173], v[172:173], v[218:219], v[218:219]
    v_pk_fma_f32 v[174:175], v[174:175], v[218:219], v[218:219]
    v_rcp_f32 v160, v160
    v_rcp_f32 v161, v161
    v_rcp_f32 v162, v162
    v_rcp_f32 v163, v163
    v_rcp_f32 v164, v164
    v_rcp_f32 v165, v165
    v_rcp_f32 v166, v166
    v_rcp_f32 v167, v167
    v_rcp_f32 v168, v168
    v_rcp_f32 v169, v169
    v_rcp_f32 v170, v170
    v_rcp_f32 v171, v171
    v_rcp_f32 v172, v172
    v_rcp_f32 v173, v173
    v_rcp_f32 v174, v174
    v_rcp_f32 v175, v175
    v_pk_mul_f32 v[160:161], v[160:161], v[64:65]
    v_pk_mul_f32 v[162:163], v[162:163], v[66:67]
    v_pk_mul_f32 v[164:165], v[164:165], v[80:81]
    v_pk_mul_f32 v[166:167], v[166:167], v[82:83]
    v_pk_mul_f32 v[168:169], v[168:169], v[68:69]
    v_pk_mul_f32 v[170:171], v[170:171], v[70:71]
    v_pk_mul_f32 v[172:173], v[172:173], v[84:85]
    v_pk_mul_f32 v[174:175], v[174:175], v[86:87]
    v_cvt_pk_bf16_f32 v192, v160, v161
    v_cvt_pk_bf16_f32 v193, v162, v163
    v_cvt_pk_bf16_f32 v194, v164, v165
    v_cvt_pk_bf16_f32 v195, v166, v167
    v_cvt_pk_bf16_f32 v196, v168, v169
    v_cvt_pk_bf16_f32 v197, v170, v171
    v_cvt_pk_bf16_f32 v198, v172, v173
    v_cvt_pk_bf16_f32 v199, v174, v175
    ds_write_b128 v205, v[192:195] offset:32768
    ds_write_b128 v205, v[196:199] offset:33792
    v_pk_mul_f32 v[176:177], v[72:73], v[72:73]
    v_pk_mul_f32 v[178:179], v[74:75], v[74:75]
    v_pk_mul_f32 v[180:181], v[88:89], v[88:89]
    v_pk_mul_f32 v[182:183], v[90:91], v[90:91]
    v_pk_mul_f32 v[184:185], v[76:77], v[76:77]
    v_pk_mul_f32 v[186:187], v[78:79], v[78:79]
    v_pk_mul_f32 v[188:189], v[92:93], v[92:93]
    v_pk_mul_f32 v[190:191], v[94:95], v[94:95]
    v_pk_fma_f32 v[176:177], v[176:177], v[142:143], v[212:213]
    v_pk_fma_f32 v[178:179], v[178:179], v[142:143], v[212:213]
    v_pk_fma_f32 v[180:181], v[180:181], v[142:143], v[212:213]
    v_pk_fma_f32 v[182:183], v[182:183], v[142:143], v[212:213]
    v_pk_fma_f32 v[184:185], v[184:185], v[144:145], v[214:215]
    v_pk_fma_f32 v[186:187], v[186:187], v[144:145], v[214:215]
    v_pk_fma_f32 v[188:189], v[188:189], v[144:145], v[214:215]
    v_pk_fma_f32 v[190:191], v[190:191], v[144:145], v[214:215]
    v_pk_mul_f32 v[176:177], v[176:177], v[72:73]
    v_pk_mul_f32 v[178:179], v[178:179], v[74:75]
    v_pk_mul_f32 v[180:181], v[180:181], v[88:89]
    v_pk_mul_f32 v[182:183], v[182:183], v[90:91]
    v_pk_mul_f32 v[184:185], v[184:185], v[76:77]
    v_pk_mul_f32 v[186:187], v[186:187], v[78:79]
    v_pk_mul_f32 v[188:189], v[188:189], v[92:93]
    v_pk_mul_f32 v[190:191], v[190:191], v[94:95]
    v_exp_f32 v176, v176
    v_exp_f32 v177, v177
    v_exp_f32 v178, v178
    v_exp_f32 v179, v179
    v_exp_f32 v180, v180
    v_exp_f32 v181, v181
    v_exp_f32 v182, v182
    v_exp_f32 v183, v183
    v_exp_f32 v184, v184
    v_exp_f32 v185, v185
    v_exp_f32 v186, v186
    v_exp_f32 v187, v187
    v_exp_f32 v188, v188
    v_exp_f32 v189, v189
    v_exp_f32 v190, v190
    v_exp_f32 v191, v191
    v_pk_fma_f32 v[176:177], v[176:177], v[146:147], v[146:147]
    v_pk_fma_f32 v[178:179], v[178:179], v[146:147], v[146:147]
    v_pk_fma_f32 v[180:181], v[180:181], v[146:147], v[146:147]
    v_pk_fma_f32 v[182:183], v[182:183], v[146:147], v[146:147]
    v_pk_fma_f32 v[184:185], v[184:185], v[148:149], v[148:149]
    v_pk_fma_f32 v[186:187], v[186:187], v[148:149], v[148:149]
    v_pk_fma_f32 v[188:189], v[188:189], v[148:149], v[148:149]
    v_pk_fma_f32 v[190:191], v[190:191], v[148:149], v[148:149]
    v_rcp_f32 v176, v176
    v_rcp_f32 v177, v177
    v_rcp_f32 v178, v178
    v_rcp_f32 v179, v179
    v_rcp_f32 v180, v180
    v_rcp_f32 v181, v181
    v_rcp_f32 v182, v182
    v_rcp_f32 v183, v183
    v_rcp_f32 v184, v184
    v_rcp_f32 v185, v185
    v_rcp_f32 v186, v186
    v_rcp_f32 v187, v187
    v_rcp_f32 v188, v188
    v_rcp_f32 v189, v189
    v_rcp_f32 v190, v190
    v_rcp_f32 v191, v191
    v_pk_mul_f32 v[176:177], v[176:177], v[72:73]
    v_pk_mul_f32 v[178:179], v[178:179], v[74:75]
    v_pk_mul_f32 v[180:181], v[180:181], v[88:89]
    v_pk_mul_f32 v[182:183], v[182:183], v[90:91]
    v_pk_mul_f32 v[184:185], v[184:185], v[76:77]
    v_pk_mul_f32 v[186:187], v[186:187], v[78:79]
    v_pk_mul_f32 v[188:189], v[188:189], v[92:93]
    v_pk_mul_f32 v[190:191], v[190:191], v[94:95]
    v_cvt_pk_bf16_f32 v150, v176, v177
    v_cvt_pk_bf16_f32 v151, v178, v179
    v_cvt_pk_bf16_f32 v152, v180, v181
    v_cvt_pk_bf16_f32 v153, v182, v183
    v_cvt_pk_bf16_f32 v154, v184, v185
    v_cvt_pk_bf16_f32 v155, v186, v187
    v_cvt_pk_bf16_f32 v156, v188, v189
    v_cvt_pk_bf16_f32 v157, v190, v191
    ds_write_b128 v205, v[150:153] offset:34816
    ds_write_b128 v205, v[154:157] offset:35840
    v_pk_mul_f32 v[160:161], v[96:97], v[96:97]
    v_pk_mul_f32 v[162:163], v[98:99], v[98:99]
    v_pk_mul_f32 v[164:165], v[100:101], v[100:101]
    v_pk_mul_f32 v[166:167], v[102:103], v[102:103]
    v_pk_mul_f32 v[168:169], v[104:105], v[104:105]
    v_pk_mul_f32 v[170:171], v[106:107], v[106:107]
    v_pk_mul_f32 v[172:173], v[108:109], v[108:109]
    v_pk_mul_f32 v[174:175], v[110:111], v[110:111]
    s_waitcnt lgkmcnt(0)
    v_mov_b32 v255, 3
    s_mov_b64 exec, 1
    ds_write_b32 v201, v255 offset:16
    s_mov_b64 exec, -1
    v_pk_fma_f32 v[160:161], v[160:161], v[138:139], v[208:209]
    v_pk_fma_f32 v[162:163], v[162:163], v[138:139], v[208:209]
    v_pk_fma_f32 v[164:165], v[164:165], v[140:141], v[210:211]
    v_pk_fma_f32 v[166:167], v[166:167], v[140:141], v[210:211]
    v_pk_fma_f32 v[168:169], v[168:169], v[142:143], v[212:213]
    v_pk_fma_f32 v[170:171], v[170:171], v[142:143], v[212:213]
    v_pk_fma_f32 v[172:173], v[172:173], v[144:145], v[214:215]
    v_pk_fma_f32 v[174:175], v[174:175], v[144:145], v[214:215]
    v_pk_mul_f32 v[160:161], v[160:161], v[96:97]
    v_pk_mul_f32 v[162:163], v[162:163], v[98:99]
    v_pk_mul_f32 v[164:165], v[164:165], v[100:101]
    v_pk_mul_f32 v[166:167], v[166:167], v[102:103]
    v_pk_mul_f32 v[168:169], v[168:169], v[104:105]
    v_pk_mul_f32 v[170:171], v[170:171], v[106:107]
    v_pk_mul_f32 v[172:173], v[172:173], v[108:109]
    v_pk_mul_f32 v[174:175], v[174:175], v[110:111]
    v_exp_f32 v160, v160
    v_exp_f32 v161, v161
    v_exp_f32 v162, v162
    v_exp_f32 v163, v163
    v_exp_f32 v164, v164
    v_exp_f32 v165, v165
    v_exp_f32 v166, v166
    v_exp_f32 v167, v167
    v_exp_f32 v168, v168
    v_exp_f32 v169, v169
    v_exp_f32 v170, v170
    v_exp_f32 v171, v171
    v_exp_f32 v172, v172
    v_exp_f32 v173, v173
    v_exp_f32 v174, v174
    v_exp_f32 v175, v175
    v_pk_fma_f32 v[160:161], v[160:161], v[216:217], v[216:217]
    v_pk_fma_f32 v[162:163], v[162:163], v[216:217], v[216:217]
    v_pk_fma_f32 v[164:165], v[164:165], v[218:219], v[218:219]
    v_pk_fma_f32 v[166:167], v[166:167], v[218:219], v[218:219]
    v_pk_fma_f32 v[168:169], v[168:169], v[146:147], v[146:147]
    v_pk_fma_f32 v[170:171], v[170:171], v[146:147], v[146:147]
    v_pk_fma_f32 v[172:173], v[172:173], v[148:149], v[148:149]
    v_pk_fma_f32 v[174:175], v[174:175], v[148:149], v[148:149]
    v_rcp_f32 v160, v160
    v_rcp_f32 v161, v161
    v_rcp_f32 v162, v162
    v_rcp_f32 v163, v163
    v_rcp_f32 v164, v164
    v_rcp_f32 v165, v165
    v_rcp_f32 v166, v166
    v_rcp_f32 v167, v167
    v_rcp_f32 v168, v168
    v_rcp_f32 v169, v169
    v_rcp_f32 v170, v170
    v_rcp_f32 v171, v171
    v_rcp_f32 v172, v172
    v_rcp_f32 v173, v173
    v_rcp_f32 v174, v174
    v_rcp_f32 v175, v175
    v_pk_mul_f32 v[160:161], v[160:161], v[96:97]
    v_pk_mul_f32 v[162:163], v[162:163], v[98:99]
    v_pk_mul_f32 v[164:165], v[164:165], v[100:101]
    v_pk_mul_f32 v[166:167], v[166:167], v[102:103]
    v_pk_mul_f32 v[168:169], v[168:169], v[104:105]
    v_pk_mul_f32 v[170:171], v[170:171], v[106:107]
    v_pk_mul_f32 v[172:173], v[172:173], v[108:109]
    v_pk_mul_f32 v[174:175], v[174:175], v[110:111]
    v_cvt_pk_bf16_f32 v128, v160, v161
    v_cvt_pk_bf16_f32 v129, v162, v163
    v_cvt_pk_bf16_f32 v130, v164, v165
    v_cvt_pk_bf16_f32 v131, v166, v167
    v_cvt_pk_bf16_f32 v132, v168, v169
    v_cvt_pk_bf16_f32 v133, v170, v171
    v_cvt_pk_bf16_f32 v134, v172, v173
    v_cvt_pk_bf16_f32 v135, v174, v175
    v_permlane32_swap_b32 v128, v130
    v_permlane32_swap_b32 v129, v131
    v_permlane32_swap_b32 v132, v134
    v_permlane32_swap_b32 v133, v135
    s_setprio 0
    buffer_load_dword v246, v247, s[4:7], s97 offen sc1
    s_waitcnt vmcnt(0)
    s_mov_b32 s54, 20000
pl_7:
    v_cmp_gt_u32 vcc, 1, v246
    s_cbranch_vccz ok_8
    s_sub_u32 s54, s54, 1
    s_cbranch_scc1 ok_8
    buffer_load_dword v246, v247, s[4:7], s97 offen sc1
    s_waitcnt vmcnt(0)
    s_branch pl_7
ok_8:
    s_mov_b32 s54, 1000000
sp_9:
    ds_read_b32 v203, v202 offset:0
    s_waitcnt lgkmcnt(0)
    v_cmp_gt_u32 vcc, 1, v203
    s_cbranch_vccz ok_10
    s_sub_u32 s54, s54, 1
    s_cbranch_scc0 sp_9
ok_10:
    s_add_u32 m0, s94, 49152
    s_cmp_lt_u32 s33, 1-zz0
    s_cselect_b32 s95, 1, 0
    s_mul_i32 s96, s95, 458752
    s_mul_i32 s95, s95, 57344
    s_add_u32 s96, s96, s49
    s_add_u32 s95, s95, s48
    buffer_load_dwordx4 v240, s[4:7], s95 offen offset:0 sc1 lds
    buffer_load_dwordx4 v240, s[4:7], s95 offen offset:1024 sc1 lds
    buffer_load_dwordx4 v240, s[4:7], s95 offen offset:2048 sc1 lds
    buffer_load_dwordx4 v240, s[4:7], s95 offen offset:3072 sc1 lds
    s_bfe_u32 s50, s35, 0x20002
    s_lshl_b32 s51, s3, 6
    v_add_u32 v89, s51, v223
    v_xor_b32 v88, s50, v89
    s_mov_b32 s50, 135168
    v_lshl_add_u32 v88, v88, 2, s50
    v_lshlrev_b32 v89, 4, v89
    ds_read2st64_b32 v[64:65], v88 offset0:0 offset1:17
    ds_read2st64_b32 v[66:67], v88 offset0:34 offset1:51
    ds_read2st64_b32 v[68:69], v88 offset0:4 offset1:21
    ds_read2st64_b32 v[70:71], v88 offset0:38 offset1:55
    ds_read2st64_b32 v[72:73], v88 offset0:8 offset1:25
    ds_read2st64_b32 v[74:75], v88 offset0:42 offset1:59
    ds_read2st64_b32 v[76:77], v88 offset0:12 offset1:29
    ds_read2st64_b32 v[78:79], v88 offset0:46 offset1:63
    v_mov_b32 v90, v202
    v_mov_b32 v88, v201
    buffer_store_dwordx4 v[112:115], v205, s[4:7], s46 offen offset:0 sc1
    buffer_store_dwordx4 v[116:119], v205, s[4:7], s46 offen offset:1024 sc1
    buffer_store_dwordx4 v[120:123], v205, s[4:7], s46 offen offset:2048 sc1
    buffer_store_dwordx4 v[124:127], v205, s[4:7], s46 offen offset:3072 sc1
    s_waitcnt vmcnt(4)
    v_mov_b32 v255, 4
    s_mov_b64 exec, 1
    ds_write_b32 v88, v255 offset:16
    s_mov_b64 exec, -1
    s_mov_b32 s54, 1000000
sp_11:
    ds_read_b32 v91, v90 offset:0
    s_waitcnt lgkmcnt(0)
    v_cmp_gt_u32 vcc, 2, v91
    s_cbranch_vccz ok_12
    s_sub_u32 s54, s54, 1
    s_cbranch_scc0 sp_11
ok_12:
    s_add_u32 m0, s94, 65536
    s_cmp_lt_u32 s33, 2
    s_cselect_b32 s95, 2, 1
    s_mul_i32 s96, s95, 458752
    s_mul_i32 s95, s95, 57344
    s_add_u32 s96, s96, s49
    s_add_u32 s95, s95, s48
    buffer_load_dwordx4 v241, s[12:15], s96 offen offset:0 lds
    buffer_load_dwordx4 v242, s[12:15], s96 offen offset:1024 lds
    buffer_load_dwordx4 v243, s[12:15], s96 offen offset:2048 lds
    buffer_load_dwordx4 v244, s[12:15], s96 offen offset:3072 lds
    s_add_u32 m0, s94, 0
    s_cmp_lt_u32 s33, 2
    s_cselect_b32 s95, 2, 1
    s_mul_i32 s96, s95, 458752
    s_mul_i32 s95, s95, 57344
    s_add_u32 s96, s96, s49
    s_add_u32 s95, s95, s48
    buffer_load_dwordx4 v240, s[4:7], s95 offen offset:0 sc1 lds
    buffer_load_dwordx4 v240, s[4:7], s95 offen offset:1024 sc1 lds
    buffer_load_dwordx4 v240, s[4:7], s95 offen offset:2048 sc1 lds
    buffer_load_dwordx4 v240, s[4:7], s95 offen offset:3072 sc1 lds
    s_mov_b32 s54, 1000000
sp_13:
    ds_read_b32 v91, v90 offset:0
    s_waitcnt lgkmcnt(0)
    v_cmp_gt_u32 vcc, 3, v91
    s_cbranch_vccz ok_14
    s_sub_u32 s54, s54, 1
    s_cbranch_scc0 sp_13
ok_14:
    s_add_u32 m0, s94, 81920
    s_cmp_lt_u32 s33, 3
    s_cselect_b32 s95, 3, 2
    s_mul_i32 s96, s95, 458752
    s_mul_i32 s95, s95, 57344
    s_add_u32 s96, s96, s49
    s_add_u32 s95, s95, s48
    buffer_load_dwordx4 v241, s[12:15], s96 offen offset:0 lds
    buffer_load_dwordx4 v242, s[12:15], s96 offen offset:1024 lds
    buffer_load_dwordx4 v243, s[12:15], s96 offen offset:2048 lds
    buffer_load_dwordx4 v244, s[12:15], s96 offen offset:3072 lds
    s_add_u32 m0, s94, 16384
    s_cmp_lt_u32 s33, 3
    s_cselect_b32 s95, 3, 2
    s_mul_i32 s96, s95, 458752
    s_mul_i32 s95, s95, 57344
    s_add_u32 s96, s96, s49
    s_add_u32 s95, s95, s48
    buffer_load_dwordx4 v240, s[4:7], s95 offen offset:0 sc1 lds
    buffer_load_dwordx4 v240, s[4:7], s95 offen offset:1024 sc1 lds
    buffer_load_dwordx4 v240, s[4:7], s95 offen offset:2048 sc1 lds
    buffer_load_dwordx4 v240, s[4:7], s95 offen offset:3072 sc1 lds
    s_waitcnt vmcnt(8)
    v_mov_b32 v255, 5
    s_mov_b64 exec, 1
    ds_write_b32 v88, v255 offset:16
    s_mov_b64 exec, -1
    s_mov_b32 s54, 1000000
sp_25:
    ds_read_b32 v91, v90 offset:0
    s_waitcnt lgkmcnt(0)
    v_cmp_gt_u32 vcc, 4, v91
    s_cbranch_vccz ok_26
    s_sub_u32 s54, s54, 1
    s_cbranch_scc0 sp_25
ok_26:
    s_add_u32 m0, s94, 32768
    s_cmp_lt_u32 s33, 4-zz0
    s_cselect_b32 s89, 4, 3
    s_mul_i32 s90, s89, 458752
    s_mul_i32 s89, s89, 57344
    s_add_u32 s90, s90, s49
    s_add_u32 s89, s89, s48
    buffer_load_dwordx4 v240, s[4:7], s89 offen offset:0 sc1 lds
    buffer_load_dwordx4 v240, s[4:7], s89 offen offset:1024 sc1 lds
    buffer_load_dwordx4 v240, s[4:7], s89 offen offset:2048 sc1 lds
    buffer_load_dwordx4 v240, s[4:7], s89 offen offset:3072 sc1 lds
    s_cmp_lt_u32 s33, 5-zz0
    s_cselect_b32 s95, 5, 4
    s_mul_i32 s96, s95, 458752
    s_mul_i32 s95, s95, 57344
    s_add_u32 s96, s96, s49
    s_add_u32 s95, s95, s48
    s_add_u32 m0, s94, 98304
    s_nop 0
    buffer_load_dwordx4 v241, s[12:15], s90 offen offset:0 lds
    buffer_load_dwordx4 v242, s[12:15], s90 offen offset:1024 lds
    buffer_load_dwordx4 v243, s[12:15], s90 offen offset:2048 lds
    ds_read_b32 v91, v90
    buffer_load_dwordx4 v244, s[12:15], s90 offen offset:3072 lds
    s_mul_i32 s53, s35, 16640
    s_add_u32 s53, s53, 27262976
    s_waitcnt lgkmcnt(0)
    buffer_store_dwordx4 v[64:67], v89, s[4:7], s53 offen sc1
    s_add_u32 s53, s53, 4096
    buffer_store_dwordx4 v[68:71], v89, s[4:7], s53 offen sc1
    s_add_u32 s53, s53, 4096
    buffer_store_dwordx4 v[72:75], v89, s[4:7], s53 offen sc1
    s_add_u32 s53, s53, 4096
    buffer_store_dwordx4 v[76:79], v89, s[4:7], s53 offen sc1
    s_add_u32 m0, s94, 49152
    s_waitcnt lgkmcnt(0)
    v_cmp_gt_u32 vcc, 5, v91
    s_cbranch_vccnz sl_27
bk_29:
    buffer_load_dwordx4 v240, s[4:7], s95 offen offset:0 sc1 lds
    s_waitcnt vmcnt(29)
    s_mov_b64 exec, 1
    v_mov_b32 v255, 2
    buffer_store_dword v255, off, s[4:7], s40 sc1
    s_mov_b64 exec, -1
    v_and_b32 v160, 31, v223
    v_lshrrev_b32 v161, 5, v223
    v_lshrrev_b32 v248, 2, v223
    v_lshlrev_b32 v253, 5, v160
    v_lshl_add_u32 v253, v161, 4, v253
    v_lshlrev_b32 v254, 11, v248
    buffer_load_dwordx4 v240, s[4:7], s95 offen offset:1024 sc1 lds
    v_mul_u32_u24 v248, 16640, v248
    v_and_b32 v164, 3, v223
    v_lshl_add_u32 v248, v164, 4, v248
    v_lshrrev_b32 v165, 4, v223
    v_xor_b32 v164, v164, v165
    v_lshl_add_u32 v254, v164, 4, v254
    v_bfe_u32 v250, v223, 2, 2
    v_xor_b32 v250, s3, v250
    v_lshlrev_b32 v250, 4, v250
    v_lshl_add_u32 v250, v160, 6, v250
    buffer_load_dwordx4 v240, s[4:7], s95 offen offset:2048 sc1 lds
    v_lshl_add_u32 v250, v161, 12, v250
    v_add_u32 v250, 135168, v250
    v_lshlrev_b32 v252, 31, v223
    v_xor_b32 v252, 1.0, v252
    v_subrev_u32 v164, 1, v161
    v_and_b32 v162, 19, v160
    v_bfe_u32 v163, v160, 2, 1
    v_and_b32 v252, v252, v164
    v_lshl_or_b32 v162, v163, 3, v162
    buffer_load_dwordx4 v240, s[4:7], s95 offen offset:3072 sc1 lds
    s_cmp_lt_u32 s33, 6
    s_cselect_b32 s89, 6, 5
    s_mul_i32 s90, s89, 458752
    s_mul_i32 s89, s89, 57344
    s_add_u32 s90, s90, s49
    s_add_u32 s89, s89, s48
    v_bfe_u32 v163, v160, 3, 1
    v_lshl_or_b32 v162, v163, 2, v162
    v_lshlrev_b32 v245, 4, v162
    v_lshl_or_b32 v245, v161, 9, v245
    v_cvt_f32_u32 v162, v162
    v_cvt_f32_u32 v163, v161
    v_cvt_f32_u32 v251, s37
    v_mul_f32 v162, 0x3d000000, v162
    v_mul_f32 v163, 4.0, v163
    s_add_u32 m0, s94, 114688
    s_nop 0
    buffer_load_dwordx4 v241, s[12:15], s96 offen offset:0 lds
    v_mul_f32 v251, 0x3a000000, v251
    v_fma_f32 v163, v163, v162, v251
    v_mov_b32 v164, v163
    v_fmamk_f32 v165, v162, 0x3f800000, v163
    v_fmamk_f32 v166, v162, 0x40000000, v163
    v_fmamk_f32 v167, v162, 0x40400000, v163
    v_cos_f32 v168, v164
    v_sin_f32 v172, v164
    buffer_load_dwordx4 v242, s[12:15], s96 offen offset:1024 lds
    v_cos_f32 v169, v165
    v_sin_f32 v173, v165
    v_cos_f32 v170, v166
    v_sin_f32 v174, v166
    v_cos_f32 v171, v167
    buffer_load_dwordx4 v243, s[12:15], s96 offen offset:2048 lds
    v_sin_f32_e64 v175, v167
    v_cvt_pk_bf16_f32 v224, -v172, v168
    v_cvt_pk_bf16_f32 v232, v168, v172
    v_cvt_pk_bf16_f32 v225, -v173, v169
    v_cvt_pk_bf16_f32 v233, v169, v173
    v_cvt_pk_bf16_f32 v226, -v174, v170
    v_cvt_pk_bf16_f32 v234, v170, v174
    buffer_load_dwordx4 v244, s[12:15], s96 offen offset:3072 lds
    v_cvt_pk_bf16_f32 v227, -v175, v171
    v_cvt_pk_bf16_f32 v235, v171, v175
    v_fmamk_f32 v164, v162, 0x41000000, v163
    v_fmamk_f32 v165, v162, 0x41100000, v163
    v_fmamk_f32 v166, v162, 0x41200000, v163
    v_fmamk_f32 v167, v162, 0x41300000, v163
    v_cos_f32 v168, v164
    v_sin_f32 v172, v164
    v_cos_f32 v169, v165
    v_sin_f32 v173, v165
    v_cos_f32 v170, v166
    v_sin_f32 v174, v166
    v_cos_f32 v171, v167
    v_sin_f32 v175, v167
    s_add_u32 m0, s94, 0
    s_waitcnt vmcnt(21)
    s_barrier
    buffer_load_dwordx4 v240, s[4:7], s89 offen offset:0 sc1 lds
    s_waitcnt vmcnt(10)
    s_mov_b64 exec, 1
    v_mov_b32 v255, 3
    buffer_store_dword v255, off, s[4:7], s41 sc1
    s_mov_b64 exec, -1
    buffer_load_dwordx4 v240, s[4:7], s89 offen offset:1024 sc1 lds
    v_cvt_pk_bf16_f32 v228, -v172, v168
    buffer_load_dwordx4 v240, s[4:7], s89 offen offset:2048 sc1 lds
    v_cvt_pk_bf16_f32 v236, v168, v172
    v_cvt_pk_bf16_f32 v229, -v173, v169
    buffer_load_dwordx4 v240, s[4:7], s89 offen offset:3072 sc1 lds
    s_cmp_lt_u32 s33, 7
    s_cselect_b32 s95, 7, 6
    s_mul_i32 s96, s95, 458752
    s_mul_i32 s95, s95, 57344
    s_add_u32 s96, s96, s49
    s_add_u32 s95, s95, s48
    v_cvt_pk_bf16_f32 v237, v169, v173
    v_cvt_pk_bf16_f32 v230, -v174, v170
    s_add_u32 m0, s94, 65536
    s_nop 0
    buffer_load_dwordx4 v241, s[12:15], s90 offen offset:0 lds
    v_cvt_pk_bf16_f32 v238, v170, v174
    v_cvt_pk_bf16_f32 v231, -v175, v171
    buffer_load_dwordx4 v242, s[12:15], s90 offen offset:1024 lds
    v_cvt_pk_bf16_f32 v239, v171, v175
    v_add_u32 v85, 131072, v245
    buffer_load_dwordx4 v243, s[12:15], s90 offen offset:2048 lds
    v_add_u32 v81, 152576, v240
    v_lshlrev_b32_e64 v249, 2, v223
    buffer_load_dwordx4 v244, s[12:15], s90 offen offset:3072 lds
    ds_read_b128 v[48:51], v81 offset:0
    ds_read_b128 v[52:55], v81 offset:1024
    ds_read_b128 v[56:59], v81 offset:2048
    ds_read_b128 v[60:63], v81 offset:3072
    ds_read_b128 v[0:3], v85 offset:0
    ds_read_b128 v[4:7], v85 offset:1024
    ds_read_b128 v[8:11], v85 offset:2048
    ds_read_b128 v[12:15], v85 offset:3072
    buffer_store_dwordx4 v[192:195], v205, s[4:7], s47 offen offset:0 sc1
    buffer_store_dwordx4 v[196:199], v205, s[4:7], s47 offen offset:1024 sc1
    buffer_store_dwordx4 v[150:153], v205, s[4:7], s47 offen offset:2048 sc1
    s_add_u32 m0, s94, 16384
    s_waitcnt vmcnt(25)
    s_barrier
    buffer_load_dwordx4 v240, s[4:7], s95 offen offset:0 sc1 lds
    buffer_load_dwordx4 v240, s[4:7], s95 offen offset:1024 sc1 lds
    buffer_load_dwordx4 v240, s[4:7], s95 offen offset:2048 sc1 lds
    buffer_load_dwordx4 v240, s[4:7], s95 offen offset:3072 sc1 lds
    s_cmp_lt_u32 s33, 1-zz0
    s_cselect_b32 s89, 1, 0
    s_mul_i32 s90, s89, 458752
    s_mul_i32 s89, s89, 57344
    s_add_u32 s90, s90, s49
    s_add_u32 s89, s89, s48
    s_add_u32 s90, s90, 65536
    s_add_u32 s89, s89, 16384
    s_add_u32 m0, s94, 81920
    s_nop 0
    buffer_load_dwordx4 v241, s[12:15], s96 offen offset:0 lds
    buffer_load_dwordx4 v242, s[12:15], s96 offen offset:1024 lds
    buffer_load_dwordx4 v243, s[12:15], s96 offen offset:2048 lds
    buffer_load_dwordx4 v244, s[12:15], s96 offen offset:3072 lds
    buffer_load_dword v246, v247, s[4:7], s97 offen sc1
    buffer_store_dwordx4 v[154:157], v205, s[4:7], s47 offen offset:3072 sc1
    buffer_store_dwordx4 v[128:131], v206, s[4:7], s39 offen offset:0 sc1
    buffer_store_dwordx4 v[132:135], v206, s[4:7], s39 offen offset:2048 sc1
    s_add_u32 m0, s94, 98304
    s_waitcnt vmcnt(24)
    s_barrier
    buffer_load_dwordx4 v241, s[12:15], s90 offen offset:0 lds
    buffer_load_dwordx4 v242, s[12:15], s90 offen offset:1024 lds
    buffer_load_dwordx4 v243, s[12:15], s90 offen offset:2048 lds
    buffer_load_dwordx4 v244, s[12:15], s90 offen offset:3072 lds
    s_cmp_lt_u32 s33, 1-zz0
    s_cselect_b32 s95, 1, 0
    s_mul_i32 s96, s95, 458752
    s_mul_i32 s95, s95, 57344
    s_add_u32 s96, s96, s49
    s_add_u32 s95, s95, s48
    s_add_u32 s96, s96, 65536
    s_add_u32 s95, s95, 16384
    s_waitcnt vmcnt(7)
    s_mov_b32 s54, 20000
pl_15:
    v_cmp_gt_u32_e64 vcc, 2, v246
    s_cbranch_vccz ok_16
    s_sub_u32 s54, s54, 1-zz0
    s_cbranch_scc1 ok_16
    buffer_load_dword v246, v247, s[4:7], s97 offen sc1
    s_waitcnt vmcnt(0)
    s_branch pl_15
ok_16:
    s_add_u32 m0, s94, 32768
    s_waitcnt vmcnt(19)
    s_barrier
    buffer_load_dwordx4 v240, s[4:7], s95 offen offset:0 sc1 lds
    buffer_load_dword v222, v249, s[4:7], s100 offen sc1
    buffer_load_dwordx4 v240, s[4:7], s95 offen offset:1024 sc1 lds
    buffer_load_dwordx4 v240, s[4:7], s95 offen offset:2048 sc1 lds
    buffer_load_dwordx4 v240, s[4:7], s95 offen offset:3072 sc1 lds
    s_cmp_lt_u32 s33, 3-zz0
    s_cselect_b32 s89, 3, 2
    s_mul_i32 s90, s89, 458752
    s_mul_i32 s89, s89, 57344
    s_add_u32 s90, s90, s49
    s_add_u32 s89, s89, s48
    s_add_u32 s90, s90, 65536
    s_add_u32 s89, s89, 16384
    s_add_u32 m0, s94, 49152
    s_cmp_lt_u32 s33, 2-zz0
    s_cselect_b32 s95, 2, 1
    s_mul_i32 s96, s95, 458752
    s_mul_i32 s95, s95, 57344
    s_add_u32 s96, s96, s49
    s_add_u32 s95, s95, s48
    s_add_u32 s96, s96, 65536
    s_add_u32 s95, s95, 16384
    buffer_load_dwordx4 v240, s[4:7], s95 offen offset:0 sc1 lds
    buffer_load_dwordx4 v240, s[4:7], s95 offen offset:1024 sc1 lds
    buffer_load_dwordx4 v240, s[4:7], s95 offen offset:2048 sc1 lds
    buffer_load_dwordx4 v240, s[4:7], s95 offen offset:3072 sc1 lds
    ds_read_b128 v[32:35], v85 offset:25600
    s_add_u32 m0, s94, 114688
    s_nop 0
    buffer_load_dwordx4 v241, s[12:15], s96 offen offset:0 lds
    ds_read_b128 v[36:39], v85 offset:26624
    buffer_load_dwordx4 v242, s[12:15], s96 offen offset:1024 lds
    buffer_load_dwordx4 v243, s[12:15], s96 offen offset:2048 lds
    ds_read_b128 v[40:43], v85 offset:21504
    buffer_load_dwordx4 v244, s[12:15], s96 offen offset:3072 lds
    ds_read_b128 v[44:47], v85 offset:22528
    s_add_u32 m0, s94, 0
    s_waitcnt vmcnt(21)
    s_barrier
    buffer_load_dwordx4 v240, s[4:7], s89 offen offset:0 sc1 lds
    buffer_load_dwordx4 v240, s[4:7], s89 offen offset:1024 sc1 lds
    buffer_load_dwordx4 v240, s[4:7], s89 offen offset:2048 sc1 lds
    buffer_load_dwordx4 v240, s[4:7], s89 offen offset:3072 sc1 lds
    s_cmp_lt_u32 s33, 4-zz0
    s_cselect_b32 s95, 4, 3
    s_mul_i32 s96, s95, 458752
    s_mul_i32 s95, s95, 57344
    s_add_u32 s96, s96, s49
    s_add_u32 s95, s95, s48
    s_add_u32 s96, s96, 65536
    s_add_u32 s95, s95, 16384
    s_add_u32 m0, s94, 65536
    s_nop 0
    buffer_load_dwordx4 v241, s[12:15], s90 offen offset:0 lds
    buffer_load_dwordx4 v242, s[12:15], s90 offen offset:1024 lds
    buffer_load_dwordx4 v243, s[12:15], s90 offen offset:2048 lds
    buffer_load_dwordx4 v244, s[12:15], s90 offen offset:3072 lds
    s_waitcnt vmcnt(19)
    s_mov_b32 s54, 20000
pl_19:
    v_cmp_ne_u32_e64 vcc, 3, v222
    s_cbranch_vccz ok_20
    s_sub_u32 s54, s54, 1-zz0
    s_cbranch_scc1 ok_20
    buffer_load_dword v222, v249, s[4:7], s100 offen sc1
    s_waitcnt vmcnt(0)
    s_branch pl_19
ok_20:
    s_mul_i32 s55, s3, 1064960
    s_lshl_b32 s52, s35, 6
    s_add_u32 s55, s55, s52
    s_add_u32 s55, s55, 27262976
    s_add_u32 m0, s94, 135168
    s_nop 0
    buffer_load_dwordx4 v248, s[4:7], s55 offen sc1 lds
    s_add_u32 m0, s94, 136192
    s_add_u32 s55, s55, 266240
    buffer_load_dwordx4 v248, s[4:7], s55 offen sc1 lds
    s_add_u32 m0, s94, 137216
    s_add_u32 s55, s55, 266240
    buffer_load_dwordx4 v248, s[4:7], s55 offen sc1 lds
    s_add_u32 m0, s94, 138240
    s_add_u32 s55, s55, 266240
    buffer_load_dwordx4 v248, s[4:7], s55 offen sc1 lds
    s_lshl_b32 s50, s3, 4
    s_add_u32 s50, s50, 135168
    v_mov_b32 v84, s50
    v_cos_f32 v80, v251
    v_sin_f32 v81, v251
    s_add_u32 m0, s94, 16384
    s_waitcnt vmcnt(20)
    s_barrier
    buffer_load_dwordx4 v240, s[4:7], s95 offen offset:0 sc1 lds
    s_waitcnt vmcnt(30)
    s_mov_b64 exec, 1
    v_mov_b32 v255, 3
    buffer_store_dword v255, off, s[4:7], s40 sc1
    s_mov_b64 exec, -1
    buffer_load_dwordx4 v240, s[4:7], s95 offen offset:1024 sc1 lds
    buffer_load_dwordx4 v240, s[4:7], s95 offen offset:2048 sc1 lds
    buffer_load_dwordx4 v240, s[4:7], s95 offen offset:3072 sc1 lds
    s_cmp_lt_u32 s33, 5
    s_cselect_b32 s89, 5, 4
    s_mul_i32 s90, s89, 458752
    s_mul_i32 s89, s89, 57344
    s_add_u32 s90, s90, s49
    s_add_u32 s89, s89, s48
    s_add_u32 s90, s90, 65536
    s_add_u32 s89, s89, 16384
    s_add_u32 m0, s94, 81920
    s_nop 0
    buffer_load_dwordx4 v241, s[12:15], s96 offen offset:0 lds
    buffer_load_dwordx4 v242, s[12:15], s96 offen offset:1024 lds
    buffer_load_dwordx4 v243, s[12:15], s96 offen offset:2048 lds
    buffer_load_dwordx4 v244, s[12:15], s96 offen offset:3072 lds
    s_add_u32 m0, s94, 32768
    s_waitcnt vmcnt(21)
    s_barrier
    buffer_load_dwordx4 v240, s[4:7], s89 offen offset:0 sc1 lds
    s_waitcnt vmcnt(10)
    v_mov_b32 v255, 1
    s_mov_b64 exec, 1
    ds_write_b32 v88, v255 offset:32
    s_mov_b64 exec, -1
    buffer_load_dwordx4 v240, s[4:7], s89 offen offset:1024 sc1 lds
    buffer_load_dwordx4 v240, s[4:7], s89 offen offset:2048 sc1 lds
    buffer_load_dwordx4 v240, s[4:7], s89 offen offset:3072 sc1 lds
    s_cmp_lt_u32 s33, 6
    s_cselect_b32 s95, 6, 5
    s_mul_i32 s96, s95, 458752
    s_mul_i32 s95, s95, 57344
    s_add_u32 s96, s96, s49
    s_add_u32 s95, s95, s48
    s_add_u32 s96, s96, 65536
    s_add_u32 s95, s95, 16384
    s_add_u32 m0, s94, 98304
    s_nop 0
    buffer_load_dwordx4 v241, s[12:15], s90 offen offset:0 lds
    buffer_load_dwordx4 v242, s[12:15], s90 offen offset:1024 lds
    buffer_load_dwordx4 v243, s[12:15], s90 offen offset:2048 lds
    buffer_load_dwordx4 v244, s[12:15], s90 offen offset:3072 lds
    s_add_u32 m0, s94, 49152
    s_waitcnt vmcnt(21)
    s_barrier
    buffer_load_dwordx4 v240, s[4:7], s95 offen offset:0 sc1 lds
    s_mov_b32 s54, 1000000
sp_21:
    ds_read_b32 v89, v90 offset:32
    s_waitcnt lgkmcnt(0)
    v_cmp_gt_u32 vcc, 1, v89
    s_cbranch_vccz ok_22
    s_sub_u32 s54, s54, 1
    s_cbranch_scc0 sp_21
ok_22:
    ds_read_b128 v[64:67], v250 offset:0
    ds_read_b128 v[68:71], v250 offset:2048
    ds_read_b128 v[72:75], v250 offset:8192
    ds_read_b128 v[76:79], v250 offset:10240
    ds_read_b128 v[92:95], v84
    s_waitcnt lgkmcnt(0)
    buffer_load_dwordx4 v240, s[4:7], s95 offen offset:1024 sc1 lds
    v_writelane_b32 v64, 0, 0
    v_writelane_b32 v66, 0, 0
    v_swap_b32 v66, v68
    v_swap_b32 v67, v69
    v_swap_b32 v74, v76
    v_swap_b32 v75, v77
    buffer_load_dwordx4 v240, s[4:7], s95 offen offset:2048 sc1 lds
    s_setprio 3
    v_mfma_f32_32x32x16_bf16 v[96:111], v[64:67], v[32:35], 0
    v_mfma_f32_32x32x16_bf16 v[112:127], v[64:67], v[40:43], 0
    s_setprio 0
    buffer_load_dwordx4 v240, s[4:7], s95 offen offset:3072 sc1 lds
    s_cmp_lt_u32 s33, 7-zz0
    s_cselect_b32 s89, 7, 6
    s_mul_i32 s90, s89, 458752
    s_mul_i32 s89, s89, 57344
    s_add_u32 s90, s90, s49
    s_add_u32 s89, s89, s48
    s_add_u32 s90, s90, 65536
    s_add_u32 s89, s89, 16384
    s_setprio 3
    v_mfma_f32_32x32x16_bf16 v[96:111], v[72:75], v[36:39], v[96:111]
    s_setprio 0
    s_add_u32 m0, s94, 114688
    s_nop 0
    buffer_load_dwordx4 v241, s[12:15], s96 offen offset:0 lds
    s_setprio 3
    v_mfma_f32_32x32x16_bf16 v[112:127], v[72:75], v[44:47], v[112:127]
    v_mfma_f32_32x32x16_bf16 v[128:143], v[68:71], v[224:227], 0
    s_setprio 0
    buffer_load_dwordx4 v242, s[12:15], s96 offen offset:1024 lds
    s_setprio 3
    v_mfma_f32_32x32x16_bf16 v[144:159], v[68:71], v[232:235], 0
    s_setprio 0
    buffer_load_dwordx4 v243, s[12:15], s96 offen offset:2048 lds
    s_setprio 3
    v_mfma_f32_32x32x16_bf16 v[128:143], v[76:79], v[228:231], v[128:143]
    v_mfma_f32_32x32x16_bf16 v[144:159], v[76:79], v[236:239], v[144:159]
    s_setprio 0
    buffer_load_dwordx4 v244, s[12:15], s96 offen offset:3072 lds
    v_and_b32 v92, 0xffff0000, v92
    v_and_b32 v93, 0xffff0000, v94
    v_lshlrev_b32_e64 v94, 16, v94
    v_mul_f32_e64 v93, v93, v80
    v_fma_f32 v93, -v94, v81, v93
    v_fmac_f32_e64 v96, v92, v252
    v_fma_mix_f32 v80, v96, v0, 0 op_sel_hi:[0,1,0]
    v_fma_mix_f32 v81, v112, v0, 0 op_sel_hi:[0,1,0]
    v_fma_mix_f32 v82, v97, v1, 0 op_sel_hi:[0,1,0]
    v_fma_mix_f32 v83, v113, v1, 0 op_sel_hi:[0,1,0]
    v_fma_mix_f32 v84, v98, v2, 0 op_sel_hi:[0,1,0]
    v_fma_mix_f32 v85, v114, v2, 0 op_sel_hi:[0,1,0]
    v_fma_mix_f32 v86, v99, v3, 0 op_sel_hi:[0,1,0]
    v_fma_mix_f32 v87, v115, v3, 0 op_sel_hi:[0,1,0]
    v_fma_mix_f32 v80, -v112, v0, v80 op_sel:[0,1,0] op_sel_hi:[0,1,0]
    v_fma_mix_f32 v81, v96, v0, v81 op_sel:[0,1,0] op_sel_hi:[0,1,0]
    v_fma_mix_f32 v82, -v113, v1, v82 op_sel:[0,1,0] op_sel_hi:[0,1,0]
    v_fma_mix_f32 v83, v97, v1, v83 op_sel:[0,1,0] op_sel_hi:[0,1,0]
    buffer_load_dword v246, v247, s[4:7], s97 offen sc1
    s_add_u32 m0, s94, 0-zz0
    s_waitcnt vmcnt(17)
    s_barrier
    buffer_load_dwordx4 v240, s[4:7], s89 offen offset:0 sc1 lds
    v_fma_mix_f32 v84, -v114, v2, v84 op_sel:[0,1,0] op_sel_hi:[0,1,0]
    v_fma_mix_f32 v85, v98, v2, v85 op_sel:[0,1,0] op_sel_hi:[0,1,0]
    v_fma_mix_f32 v86, -v115, v3, v86 op_sel:[0,1,0] op_sel_hi:[0,1,0]
    v_fma_mix_f32 v87, v99, v3, v87 op_sel:[0,1,0] op_sel_hi:[0,1,0]
    v_cvt_pk_bf16_f32 v192, v80, -v81
    v_cvt_pk_bf16_f32 v193, v82, -v83
    v_cvt_pk_bf16_f32 v194, v84, -v85
    v_cvt_pk_bf16_f32 v195, v86, -v87
    buffer_load_dwordx4 v240, s[4:7], s89 offen offset:1024 sc1 lds
    v_fma_mix_f32 v80, v100, v4, 0 op_sel_hi:[0,1,0]
    v_fma_mix_f32 v81, v116, v4, 0 op_sel_hi:[0,1,0]
    v_fma_mix_f32 v82, v101, v5, 0 op_sel_hi:[0,1,0]
    v_fma_mix_f32 v83, v117, v5, 0 op_sel_hi:[0,1,0]
    v_fma_mix_f32 v84, v102, v6, 0 op_sel_hi:[0,1,0]
    v_fma_mix_f32 v85, v118, v6, 0 op_sel_hi:[0,1,0]
    v_fma_mix_f32 v86, v103, v7, 0 op_sel_hi:[0,1,0]
    v_fma_mix_f32 v87, v119, v7, 0 op_sel_hi:[0,1,0]
    buffer_load_dwordx4 v240, s[4:7], s89 offen offset:2048 sc1 lds
    v_fma_mix_f32 v80, -v116, v4, v80 op_sel:[0,1,0] op_sel_hi:[0,1,0]
    v_fma_mix_f32 v81, v100, v4, v81 op_sel:[0,1,0] op_sel_hi:[0,1,0]
    v_fma_mix_f32 v82, -v117, v5, v82 op_sel:[0,1,0] op_sel_hi:[0,1,0]
    v_fma_mix_f32 v83, v101, v5, v83 op_sel:[0,1,0] op_sel_hi:[0,1,0]
    v_fma_mix_f32 v84, -v118, v6, v84 op_sel:[0,1,0] op_sel_hi:[0,1,0]
    v_fma_mix_f32 v85, v102, v6, v85 op_sel:[0,1,0] op_sel_hi:[0,1,0]
    v_fma_mix_f32 v86, -v119, v7, v86 op_sel:[0,1,0] op_sel_hi:[0,1,0]
    v_fma_mix_f32 v87, v103, v7, v87 op_sel:[0,1,0] op_sel_hi:[0,1,0]
    buffer_load_dwordx4 v240, s[4:7], s89 offen offset:3072 sc1 lds
    s_cmp_lt_u32 s33, 1-zz0
    s_cselect_b32 s95, 1, 0
    s_mul_i32 s96, s95, 458752
    s_mul_i32 s95, s95, 57344
    s_add_u32 s96, s96, s49
    s_add_u32 s95, s95, s48
    s_add_u32 s96, s96, 131072
    s_add_u32 s95, s95, 32768
    v_cvt_pk_bf16_f32 v196, v80, -v81
    v_cvt_pk_bf16_f32 v197, v82, -v83
    v_cvt_pk_bf16_f32 v198, v84, -v85
    v_cvt_pk_bf16_f32 v199, v86, -v87
    v_fma_mix_f32 v80, v104, v8, 0 op_sel_hi:[0,1,0]
    v_fma_mix_f32 v81, v120, v8, 0 op_sel_hi:[0,1,0]
    v_fma_mix_f32 v82, v105, v9, 0 op_sel_hi:[0,1,0]
    v_fma_mix_f32 v83, v121, v9, 0 op_sel_hi:[0,1,0]
    s_add_u32 m0, s94, 65536
    s_nop 0
    buffer_load_dwordx4 v241, s[12:15], s90 offen offset:0 lds
    v_fma_mix_f32 v84, v106, v10, 0 op_sel_hi:[0,1,0]
    v_fma_mix_f32 v85, v122, v10, 0 op_sel_hi:[0,1,0]
    v_fma_mix_f32 v86, v107, v11, 0 op_sel_hi:[0,1,0]
    v_fma_mix_f32 v87, v123, v11, 0 op_sel_hi:[0,1,0]
    v_fma_mix_f32 v80, -v120, v8, v80 op_sel:[0,1,0] op_sel_hi:[0,1,0]
    v_fma_mix_f32 v81, v104, v8, v81 op_sel:[0,1,0] op_sel_hi:[0,1,0]
    v_fma_mix_f32 v82, -v121, v9, v82 op_sel:[0,1,0] op_sel_hi:[0,1,0]
    v_fma_mix_f32 v83, v105, v9, v83 op_sel:[0,1,0] op_sel_hi:[0,1,0]
    buffer_load_dwordx4 v242, s[12:15], s90 offen offset:1024 lds
    v_fma_mix_f32 v84, -v122, v10, v84 op_sel:[0,1,0] op_sel_hi:[0,1,0]
    v_fma_mix_f32 v85, v106, v10, v85 op_sel:[0,1,0] op_sel_hi:[0,1,0]
    v_fma_mix_f32 v86, -v123, v11, v86 op_sel:[0,1,0] op_sel_hi:[0,1,0]
    v_fma_mix_f32 v87, v107, v11, v87 op_sel:[0,1,0] op_sel_hi:[0,1,0]
    v_cvt_pk_bf16_f32 v200, v80, -v81
    v_cvt_pk_bf16_f32 v201, v82, -v83
    v_cvt_pk_bf16_f32 v202, v84, -v85
    v_cvt_pk_bf16_f32 v203, v86, -v87
    buffer_load_dwordx4 v243, s[12:15], s90 offen offset:2048 lds
    v_fma_mix_f32 v80, v108, v12, 0 op_sel_hi:[0,1,0]
    v_fma_mix_f32 v81, v124, v12, 0 op_sel_hi:[0,1,0]
    v_fma_mix_f32 v82, v109, v13, 0 op_sel_hi:[0,1,0]
    v_fma_mix_f32 v83, v125, v13, 0 op_sel_hi:[0,1,0]
    v_fma_mix_f32 v84, v110, v14, 0 op_sel_hi:[0,1,0]
    v_fma_mix_f32 v85, v126, v14, 0 op_sel_hi:[0,1,0]
    v_fma_mix_f32 v86, v111, v15, 0 op_sel_hi:[0,1,0]
    v_fma_mix_f32 v87, v127, v15, 0 op_sel_hi:[0,1,0]
    buffer_load_dwordx4 v244, s[12:15], s90 offen offset:3072 lds
    v_fma_mix_f32 v80, -v124, v12, v80 op_sel:[0,1,0] op_sel_hi:[0,1,0]
    v_fma_mix_f32 v81, v108, v12, v81 op_sel:[0,1,0] op_sel_hi:[0,1,0]
    v_fma_mix_f32 v82, -v125, v13, v82 op_sel:[0,1,0] op_sel_hi:[0,1,0]
    v_fma_mix_f32 v83, v109, v13, v83 op_sel:[0,1,0] op_sel_hi:[0,1,0]
    v_fma_mix_f32 v84, -v126, v14, v84 op_sel:[0,1,0] op_sel_hi:[0,1,0]
    v_fma_mix_f32 v85, v110, v14, v85 op_sel:[0,1,0] op_sel_hi:[0,1,0]
    v_fma_mix_f32 v86, -v127, v15, v86 op_sel:[0,1,0] op_sel_hi:[0,1,0]
    v_fma_mix_f32 v87, v111, v15, v87 op_sel:[0,1,0] op_sel_hi:[0,1,0]
    v_cvt_pk_bf16_f32 v204, v80, -v81
    v_cvt_pk_bf16_f32 v205, v82, -v83
    v_cvt_pk_bf16_f32 v206, v84, -v85
    v_cvt_pk_bf16_f32 v207, v86, -v87
    s_setprio 3
    v_mfma_f32_32x32x16_bf16 v[96:111], v[192:195], v[48:51], 0
    s_setprio 0
    s_waitcnt vmcnt(8)
    s_mov_b32 s54, 20000
pl_17:
    v_cmp_gt_u32 vcc, 3, v246
    s_cbranch_vccz ok_18
    s_sub_u32 s54, s54, 1
    s_cbranch_scc1 ok_18
    buffer_load_dword v246, v247, s[4:7], s97 offen sc1
    s_waitcnt vmcnt(0)
    s_branch pl_17
ok_18:
    s_add_u32 m0, s94, 16384
    s_waitcnt vmcnt(17)
    s_barrier
    buffer_load_dwordx4 v240, s[4:7], s95 offen offset:0 sc1 lds
    s_setprio 3
    v_mfma_f32_32x32x16_bf16 v[96:111], v[196:199], v[52:55], v[96:111]
    v_mfma_f32_32x32x16_bf16 v[96:111], v[200:203], v[56:59], v[96:111]
    s_setprio 0
    buffer_load_dwordx4 v240, s[4:7], s95 offen offset:1024 sc1 lds
    s_setprio 3
    v_mfma_f32_32x32x16_bf16 v[96:111], v[204:207], v[60:63], v[96:111]
    s_setprio 0
    v_fmac_f32 v128, v93, v252
    buffer_load_dwordx4 v240, s[4:7], s95 offen offset:2048 sc1 lds
    v_fma_mix_f32 v80, v128, v0, 0 op_sel_hi:[0,1,0]
    v_fma_mix_f32 v81, v144, v0, 0 op_sel_hi:[0,1,0]
    v_fma_mix_f32 v82, v129, v1, 0 op_sel_hi:[0,1,0]
    v_fma_mix_f32 v83, v145, v1, 0 op_sel_hi:[0,1,0]
    v_fma_mix_f32 v84, v130, v2, 0 op_sel_hi:[0,1,0]
    v_fma_mix_f32 v85, v146, v2, 0 op_sel_hi:[0,1,0]
    v_fma_mix_f32 v86, v131, v3, 0 op_sel_hi:[0,1,0]
    v_fma_mix_f32 v87, v147, v3, 0 op_sel_hi:[0,1,0]
    v_fma_mix_f32 v80, -v144, v0, v80 op_sel:[0,1,0] op_sel_hi:[0,1,0]
    buffer_load_dwordx4 v240, s[4:7], s95 offen offset:3072 sc1 lds
    s_cmp_lt_u32 s33, 2-zz0
    s_cselect_b32 s89, 2, 1
    s_mul_i32 s90, s89, 458752
    s_mul_i32 s89, s89, 57344
    s_add_u32 s90, s90, s49
    s_add_u32 s89, s89, s48
    s_add_u32 s90, s90, 131072
    s_add_u32 s89, s89, 32768
    v_fma_mix_f32 v81, v128, v0, v81 op_sel:[0,1,0] op_sel_hi:[0,1,0]
    v_fma_mix_f32 v82, -v145, v1, v82 op_sel:[0,1,0] op_sel_hi:[0,1,0]
    v_fma_mix_f32 v83, v129, v1, v83 op_sel:[0,1,0] op_sel_hi:[0,1,0]
    v_fma_mix_f32 v84, -v146, v2, v84 op_sel:[0,1,0] op_sel_hi:[0,1,0]
    v_fma_mix_f32 v85, v130, v2, v85 op_sel:[0,1,0] op_sel_hi:[0,1,0]
    v_fma_mix_f32 v86, -v147, v3, v86 op_sel:[0,1,0] op_sel_hi:[0,1,0]
    v_fma_mix_f32 v87, v131, v3, v87 op_sel:[0,1,0] op_sel_hi:[0,1,0]
    v_cvt_pk_bf16_f32 v64, v80, -v81
    v_cvt_pk_bf16_f32 v65, v82, -v83
    s_add_u32 m0, s94, 81920
    s_nop 0
    buffer_load_dwordx4 v241, s[12:15], s96 offen offset:0 lds
    v_cvt_pk_bf16_f32 v66, v84, -v85
    v_cvt_pk_bf16_f32 v67, v86, -v87
    v_fma_mix_f32 v80, v132, v4, 0 op_sel_hi:[0,1,0]
    v_fma_mix_f32 v81, v148, v4, 0 op_sel_hi:[0,1,0]
    v_fma_mix_f32 v82, v133, v5, 0 op_sel_hi:[0,1,0]
    v_fma_mix_f32 v83, v149, v5, 0 op_sel_hi:[0,1,0]
    v_fma_mix_f32 v84, v134, v6, 0 op_sel_hi:[0,1,0]
    v_fma_mix_f32 v85, v150, v6, 0 op_sel_hi:[0,1,0]
    v_fma_mix_f32 v86, v135, v7, 0 op_sel_hi:[0,1,0]
    v_fma_mix_f32 v87, v151, v7, 0 op_sel_hi:[0,1,0]
    buffer_load_dwordx4 v242, s[12:15], s96 offen offset:1024 lds
    v_fma_mix_f32 v80, -v148, v4, v80 op_sel:[0,1,0] op_sel_hi:[0,1,0]
    v_fma_mix_f32 v81, v132, v4, v81 op_sel:[0,1,0] op_sel_hi:[0,1,0]
    v_fma_mix_f32 v82, -v149, v5, v82 op_sel:[0,1,0] op_sel_hi:[0,1,0]
    v_fma_mix_f32 v83, v133, v5, v83 op_sel:[0,1,0] op_sel_hi:[0,1,0]
    v_fma_mix_f32 v84, -v150, v6, v84 op_sel:[0,1,0] op_sel_hi:[0,1,0]
    v_fma_mix_f32 v85, v134, v6, v85 op_sel:[0,1,0] op_sel_hi:[0,1,0]
    v_fma_mix_f32 v86, -v151, v7, v86 op_sel:[0,1,0] op_sel_hi:[0,1,0]
    v_fma_mix_f32 v87, v135, v7, v87 op_sel:[0,1,0] op_sel_hi:[0,1,0]
    v_cvt_pk_bf16_f32 v68, v80, -v81
    buffer_load_dwordx4 v243, s[12:15], s96 offen offset:2048 lds
    v_cvt_pk_bf16_f32 v69, v82, -v83
    v_cvt_pk_bf16_f32 v70, v84, -v85
    v_cvt_pk_bf16_f32 v71, v86, -v87
    v_fma_mix_f32 v80, v136, v8, 0 op_sel_hi:[0,1,0]
    v_fma_mix_f32 v81, v152, v8, 0 op_sel_hi:[0,1,0]
    v_fma_mix_f32 v82, v137, v9, 0 op_sel_hi:[0,1,0]
    v_fma_mix_f32 v83, v153, v9, 0 op_sel_hi:[0,1,0]
    v_fma_mix_f32 v84, v138, v10, 0 op_sel_hi:[0,1,0]
    v_fma_mix_f32 v85, v154, v10, 0 op_sel_hi:[0,1,0]
    buffer_load_dwordx4 v244, s[12:15], s96 offen offset:3072 lds
    v_fma_mix_f32 v86, v139, v11, 0 op_sel_hi:[0,1,0]
    v_fma_mix_f32 v87, v155, v11, 0 op_sel_hi:[0,1,0]
    v_fma_mix_f32 v80, -v152, v8, v80 op_sel:[0,1,0] op_sel_hi:[0,1,0]
    v_fma_mix_f32 v81, v136, v8, v81 op_sel:[0,1,0] op_sel_hi:[0,1,0]
    v_fma_mix_f32 v82, -v153, v9, v82 op_sel:[0,1,0] op_sel_hi:[0,1,0]
    v_fma_mix_f32 v83, v137, v9, v83 op_sel:[0,1,0] op_sel_hi:[0,1,0]
    v_fma_mix_f32 v84, -v154, v10, v84 op_sel:[0,1,0] op_sel_hi:[0,1,0]
    v_fma_mix_f32 v85, v138, v10, v85 op_sel:[0,1,0] op_sel_hi:[0,1,0]
    v_fma_mix_f32 v86, -v155, v11, v86 op_sel:[0,1,0] op_sel_hi:[0,1,0]
    v_fma_mix_f32 v87, v139, v11, v87 op_sel:[0,1,0] op_sel_hi:[0,1,0]
    v_cvt_pk_bf16_f32 v72, v80, -v81
    v_cvt_pk_bf16_f32 v73, v82, -v83
    v_cvt_pk_bf16_f32 v74, v84, -v85
    v_cvt_pk_bf16_f32 v75, v86, -v87
    v_fma_mix_f32 v80, v140, v12, 0 op_sel_hi:[0,1,0]
    v_fma_mix_f32 v81, v156, v12, 0 op_sel_hi:[0,1,0]
    v_fma_mix_f32 v82, v141, v13, 0 op_sel_hi:[0,1,0]
    v_fma_mix_f32 v83, v157, v13, 0 op_sel_hi:[0,1,0]
    v_fma_mix_f32 v84, v142, v14, 0 op_sel_hi:[0,1,0]
    v_fma_mix_f32 v85, v158, v14, 0 op_sel_hi:[0,1,0]
    v_fma_mix_f32 v86, v143, v15, 0 op_sel_hi:[0,1,0]
    v_fma_mix_f32 v87, v159, v15, 0 op_sel_hi:[0,1,0]
    s_add_u32 m0, s94, 32768
    s_waitcnt vmcnt(17)
    s_barrier
    buffer_load_dwordx4 v240, s[4:7], s89 offen offset:0 sc1 lds
    v_fma_mix_f32 v80, -v156, v12, v80 op_sel:[0,1,0] op_sel_hi:[0,1,0]
    v_fma_mix_f32 v81, v140, v12, v81 op_sel:[0,1,0] op_sel_hi:[0,1,0]
    v_fma_mix_f32 v82, -v157, v13, v82 op_sel:[0,1,0] op_sel_hi:[0,1,0]
    v_fma_mix_f32 v83, v141, v13, v83 op_sel:[0,1,0] op_sel_hi:[0,1,0]
    v_fma_mix_f32 v84, -v158, v14, v84 op_sel:[0,1,0] op_sel_hi:[0,1,0]
    v_fma_mix_f32 v85, v142, v14, v85 op_sel:[0,1,0] op_sel_hi:[0,1,0]
    v_fma_mix_f32 v86, -v159, v15, v86 op_sel:[0,1,0] op_sel_hi:[0,1,0]
    v_fma_mix_f32 v87, v143, v15, v87 op_sel:[0,1,0] op_sel_hi:[0,1,0]
    v_cvt_pk_bf16_f32 v76, v80, -v81
    buffer_load_dwordx4 v240, s[4:7], s89 offen offset:1024 sc1 lds
    v_cvt_pk_bf16_f32 v77, v82, -v83
    v_cvt_pk_bf16_f32 v78, v84, -v85
    v_cvt_pk_bf16_f32 v79, v86, -v87
    s_setprio 3
    v_mfma_f32_32x32x16_bf16 v[128:143], v[64:67], v[48:51], 0
    s_setprio 0
    buffer_load_dwordx4 v240, s[4:7], s89 offen offset:2048 sc1 lds
    s_setprio 3
    v_mfma_f32_32x32x16_bf16 v[128:143], v[68:71], v[52:55], v[128:143]
    v_mfma_f32_32x32x16_bf16 v[128:143], v[72:75], v[56:59], v[128:143]
    s_setprio 0
    buffer_load_dwordx4 v240, s[4:7], s89 offen offset:3072 sc1 lds
    s_cmp_lt_u32 s33, 3
    s_cselect_b32 s95, 3, 2
    s_mul_i32 s96, s95, 458752
    s_mul_i32 s95, s95, 57344
    s_add_u32 s96, s96, s49
    s_add_u32 s95, s95, s48
    s_add_u32 s96, s96, 131072
    s_add_u32 s95, s95, 32768
    s_setprio 3
    v_mfma_f32_32x32x16_bf16 v[128:143], v[76:79], v[60:63], v[128:143]
    s_setprio 0
    s_add_u32 m0, s94, 98304
    s_nop 0
    buffer_load_dwordx4 v241, s[12:15], s90 offen offset:0 lds
    s_add_u32 s98, s98, 32505856
    s_add_u32 s99, s99, 32505856
    s_nop 5
    v_add_f32 v160, v96, v128
    v_add_f32 v161, v97, v129
    v_add_f32 v162, v98, v130
    v_add_f32 v163, v99, v131
    v_add_f32 v164, v100, v132
    v_add_f32 v165, v101, v133
    v_add_f32 v166, v102, v134
    v_add_f32 v167, v103, v135
    v_add_f32 v168, v104, v136
    v_add_f32 v169, v105, v137
    buffer_load_dwordx4 v242, s[12:15], s90 offen offset:1024 lds
    v_add_f32 v170, v106, v138
    v_add_f32 v171, v107, v139
    v_add_f32 v172, v108, v140
    v_add_f32 v173, v109, v141
    v_add_f32 v174, v110, v142
    v_add_f32 v175, v111, v143
    v_sub_f32 v176, v96, v128
    v_sub_f32 v177, v97, v129
    buffer_load_dwordx4 v243, s[12:15], s90 offen offset:2048 lds
    v_sub_f32 v178, v98, v130
    v_sub_f32 v179, v99, v131
    v_sub_f32 v180, v100, v132
    v_sub_f32 v181, v101, v133
    v_sub_f32 v182, v102, v134
    v_sub_f32 v183, v103, v135
    v_sub_f32 v184, v104, v136
    v_sub_f32 v185, v105, v137
    v_sub_f32 v186, v106, v138
    v_sub_f32 v187, v107, v139
    buffer_load_dwordx4 v244, s[12:15], s90 offen offset:3072 lds
    v_sub_f32 v188, v108, v140
    v_sub_f32 v189, v109, v141
    v_sub_f32 v190, v110, v142
    v_sub_f32 v191, v111, v143
    v_cvt_pk_bf16_f32 v64, v160, v161
    v_cvt_pk_bf16_f32 v65, v162, v163
    v_cvt_pk_bf16_f32 v66, v164, v165
    v_cvt_pk_bf16_f32 v67, v166, v167
    v_cvt_pk_bf16_f32 v68, v168, v169
    v_cvt_pk_bf16_f32 v69, v170, v171
    v_cvt_pk_bf16_f32 v70, v172, v173
    v_cvt_pk_bf16_f32 v71, v174, v175
    v_cvt_pk_bf16_f32 v72, v176, v177
    v_cvt_pk_bf16_f32 v73, v178, v179
    v_cvt_pk_bf16_f32 v74, v180, v181
    v_cvt_pk_bf16_f32 v75, v182, v183
    v_cvt_pk_bf16_f32 v76, v184, v185
    v_cvt_pk_bf16_f32 v77, v186, v187
    v_cvt_pk_bf16_f32 v78, v188, v189
    v_cvt_pk_bf16_f32 v79, v190, v191
    buffer_store_dwordx4 v[64:67], v253, s[4:7], s98 offen offset:0 sc1
    s_add_u32 m0, s94, 49152
    s_waitcnt vmcnt(17)
    s_barrier
    buffer_load_dwordx4 v240, s[4:7], s95 offen offset:0 sc1 lds
    buffer_store_dwordx4 v[68:71], v253, s[4:7], s98 offen offset:1024 sc1
    buffer_load_dwordx4 v240, s[4:7], s95 offen offset:1024 sc1 lds
    buffer_load_dwordx4 v240, s[4:7], s95 offen offset:2048 sc1 lds
    buffer_load_dwordx4 v240, s[4:7], s95 offen offset:3072 sc1 lds
    s_cmp_lt_u32 s33, 4-zz0
    s_cselect_b32 s89, 4, 3
    s_mul_i32 s90, s89, 458752
    s_mul_i32 s89, s89, 57344
    s_add_u32 s90, s90, s49
    s_add_u32 s89, s89, s48
    s_add_u32 s90, s90, 131072
    s_add_u32 s89, s89, 32768
    s_add_u32 m0, s94, 114688
    s_nop 0
    buffer_load_dwordx4 v241, s[12:15], s96 offen offset:0 lds
    buffer_load_dwordx4 v242, s[12:15], s96 offen offset:1024 lds
    buffer_load_dwordx4 v243, s[12:15], s96 offen offset:2048 lds
    buffer_load_dwordx4 v244, s[12:15], s96 offen offset:3072 lds
    buffer_store_dwordx4 v[72:75], v253, s[4:7], s99 offen offset:0 sc1
    buffer_store_dwordx4 v[76:79], v253, s[4:7], s99 offen offset:1024 sc1
    s_lshl_b32 s98, s44, 1
    s_add_u32 s98, s98, s34
    s_lshl_b32 s99, s32, 2
    s_add_u32 s98, s98, s99
    s_and_b32 s100, s98, 31
    s_lshl_b32 s100, s100, 7
    s_add_u32 s100, s100, 42467328
    s_lshl_b32 s98, s98, 16
    s_lshl_b32 s99, s33, 7
    s_add_u32 s98, s98, s99
    s_lshl_b32 s99, s43, 6
    s_add_u32 s98, s98, s99
    s_add_u32 s98, s98, 32505856
    s_add_u32 s99, s98, 32768
    s_add_u32 m0, s94, 0
    s_waitcnt vmcnt(20)
    s_barrier
    buffer_load_dwordx4 v240, s[4:7], s89 offen offset:0 sc1 lds
    s_waitcnt vmcnt(1)
    s_mov_b64 exec, 1
    v_mov_b32 v255, 1
    buffer_store_dword v255, off, s[4:7], s42 sc1
    s_mov_b64 exec, -1
    buffer_load_dwordx4 v240, s[4:7], s89 offen offset:1024 sc1 lds
    buffer_load_dwordx4 v240, s[4:7], s89 offen offset:2048 sc1 lds
    buffer_load_dwordx4 v240, s[4:7], s89 offen offset:3072 sc1 lds
    s_cmp_lt_u32 s33, 5
    s_cselect_b32 s95, 5, 4
    s_mul_i32 s96, s95, 458752
    s_mul_i32 s95, s95, 57344
    s_add_u32 s96, s96, s49
    s_add_u32 s95, s95, s48
    s_add_u32 s96, s96, 131072
    s_add_u32 s95, s95, 32768
    s_add_u32 m0, s94, 65536
    s_nop 0
    buffer_load_dwordx4 v241, s[12:15], s90 offen offset:0 lds
    buffer_load_dwordx4 v242, s[12:15], s90 offen offset:1024 lds
    buffer_load_dwordx4 v243, s[12:15], s90 offen offset:2048 lds
    buffer_load_dwordx4 v244, s[12:15], s90 offen offset:3072 lds
    s_add_u32 m0, s94, 16384
    s_waitcnt vmcnt(21)
    s_barrier
    buffer_load_dwordx4 v240, s[4:7], s95 offen offset:0 sc1 lds
    buffer_load_dwordx4 v240, s[4:7], s95 offen offset:1024 sc1 lds
    buffer_load_dwordx4 v240, s[4:7], s95 offen offset:2048 sc1 lds
    buffer_load_dwordx4 v240, s[4:7], s95 offen offset:3072 sc1 lds
    s_cmp_lt_u32 s33, 6
    s_cselect_b32 s89, 6, 5
    s_mul_i32 s90, s89, 458752
    s_mul_i32 s89, s89, 57344
    s_add_u32 s90, s90, s49
    s_add_u32 s89, s89, s48
    s_add_u32 s90, s90, 131072
    s_add_u32 s89, s89, 32768
    s_add_u32 m0, s94, 81920
    s_nop 0
    buffer_load_dwordx4 v241, s[12:15], s96 offen offset:0 lds
    buffer_load_dwordx4 v242, s[12:15], s96 offen offset:1024 lds
    buffer_load_dwordx4 v243, s[12:15], s96 offen offset:2048 lds
    buffer_load_dwordx4 v244, s[12:15], s96 offen offset:3072 lds
    s_add_u32 m0, s94, 32768
    s_waitcnt vmcnt(19)
    s_barrier
    buffer_load_dwordx4 v240, s[4:7], s89 offen offset:0 sc1 lds
    s_lshl_b32 s53, s34, 11
    s_add_u32 s61, s94, s53
    s_add_u32 s63, s92, s53
    s_xor_b32 s53, s53, 2048
    s_add_u32 s60, s94, s53
    s_add_u32 s62, s92, s53
    buffer_load_dwordx4 v240, s[4:7], s89 offen offset:1024 sc1 lds
    buffer_load_dwordx4 v240, s[4:7], s89 offen offset:2048 sc1 lds
    buffer_load_dwordx4 v240, s[4:7], s89 offen offset:3072 sc1 lds
    s_cmp_lt_u32 s33, 7
    s_cselect_b32 s95, 7, 6
    s_mul_i32 s96, s95, 458752
    s_mul_i32 s95, s95, 57344
    s_add_u32 s96, s96, s49
    s_add_u32 s95, s95, s48
    s_add_u32 s96, s96, 131072
    s_add_u32 s95, s95, 32768
    s_add_u32 m0, s94, 98304
    s_nop 0
    buffer_load_dwordx4 v241, s[12:15], s90 offen offset:0 lds
    buffer_load_dwordx4 v242, s[12:15], s90 offen offset:1024 lds
    buffer_load_dwordx4 v243, s[12:15], s90 offen offset:2048 lds
    buffer_load_dwordx4 v244, s[12:15], s90 offen offset:3072 lds
    s_add_u32 m0, s94, 49152
    s_waitcnt vmcnt(16)
    s_barrier
    buffer_load_dwordx4 v240, s[4:7], s95 offen offset:0 sc1 lds
    buffer_load_dwordx4 v240, s[4:7], s95 offen offset:1024 sc1 lds
    buffer_load_dwordx4 v240, s[4:7], s95 offen offset:2048 sc1 lds
    buffer_load_dwordx4 v240, s[4:7], s95 offen offset:3072 sc1 lds
    s_mov_b32 s89, 0
    s_mul_i32 s90, s89, 458752
    s_mul_i32 s89, s89, 57344
    s_add_u32 s90, s90, s93
    s_add_u32 s89, s89, s62
    s_add_u32 m0, s94, 114688
    s_nop 0
    buffer_load_dwordx4 v241, s[12:15], s96 offen offset:0 lds
    buffer_load_dwordx4 v242, s[12:15], s96 offen offset:1024 lds
    buffer_load_dwordx4 v243, s[12:15], s96 offen offset:2048 lds
    buffer_load_dwordx4 v244, s[12:15], s96 offen offset:3072 lds
    s_add_u32 m0, s60, 0
    s_waitcnt vmcnt(16)
    s_barrier
    buffer_load_dwordx4 v240, s[4:7], s89 offen offset:0 sc1 lds
    buffer_load_dwordx4 v240, s[4:7], s89 offen offset:1024 sc1 lds
    s_add_u32 m0, s94, 65536
    s_nop 0
    buffer_load_dwordx4 v241, s[12:15], s90 offen offset:0 lds
    buffer_load_dwordx4 v242, s[12:15], s90 offen offset:1024 lds
    s_mov_b32 s95, 2
    s_mul_i32 s96, s95, 458752
    s_mul_i32 s95, s95, 57344
    s_add_u32 s96, s96, s93
    s_add_u32 s95, s95, s62
    s_add_u32 s90, s90, 16384
    buffer_load_dwordx4 v243, s[12:15], s90 offen offset:2048 lds
    buffer_load_dwordx4 v244, s[12:15], s90 offen offset:3072 lds
    s_add_u32 m0, s60, 16384
    s_waitcnt vmcnt(14)
    s_barrier
    buffer_load_dwordx4 v240, s[4:7], s95 offen offset:0 sc1 lds
    buffer_load_dwordx4 v240, s[4:7], s95 offen offset:1024 sc1 lds
    s_add_u32 m0, s94, 81920
    s_nop 0
    buffer_load_dwordx4 v241, s[12:15], s96 offen offset:0 lds
    buffer_load_dwordx4 v242, s[12:15], s96 offen offset:1024 lds
    s_mov_b32 s89, 4
    s_mul_i32 s90, s89, 458752
    s_mul_i32 s89, s89, 57344
    s_add_u32 s90, s90, s93
    s_add_u32 s89, s89, s62
    s_add_u32 s96, s96, 16384
    buffer_load_dwordx4 v243, s[12:15], s96 offen offset:2048 lds
    buffer_load_dwordx4 v244, s[12:15], s96 offen offset:3072 lds
    s_add_u32 m0, s60, 32768
    s_waitcnt vmcnt(12)
    s_barrier
    buffer_load_dwordx4 v240, s[4:7], s89 offen offset:0 sc1 lds
    buffer_load_dword v222, v247, s[4:7], s100 offen sc1
    buffer_load_dwordx4 v240, s[4:7], s89 offen offset:1024 sc1 lds
    s_add_u32 m0, s94, 98304
    s_nop 0
    buffer_load_dwordx4 v241, s[12:15], s90 offen offset:0 lds
    buffer_load_dwordx4 v242, s[12:15], s90 offen offset:1024 lds
    s_mov_b32 s95, 6
    s_mul_i32 s96, s95, 458752
    s_mul_i32 s95, s95, 57344
    s_add_u32 s96, s96, s93
    s_add_u32 s95, s95, s62
    s_add_u32 s90, s90, 16384
    buffer_load_dwordx4 v243, s[12:15], s90 offen offset:2048 lds
    buffer_load_dwordx4 v244, s[12:15], s90 offen offset:3072 lds
    s_add_u32 m0, s60, 49152
    s_waitcnt vmcnt(13)
    s_barrier
    s_waitcnt vmcnt(7)
    v_mov_b32 v255, 26
    s_mov_b64 exec, 1
    ds_write_b32 v88, v255 offset:16
    s_mov_b64 exec, -1
    buffer_load_dwordx4 v240, s[4:7], s95 offen offset:0 sc1 lds
    buffer_load_dwordx4 v240, s[4:7], s95 offen offset:1024 sc1 lds
    s_add_u32 m0, s94, 114688
    s_nop 0
    buffer_load_dwordx4 v241, s[12:15], s96 offen offset:0 lds
    buffer_load_dwordx4 v242, s[12:15], s96 offen offset:1024 lds
    s_add_u32 s96, s96, 16384
    buffer_load_dwordx4 v243, s[12:15], s96 offen offset:2048 lds
    buffer_load_dwordx4 v244, s[12:15], s96 offen offset:3072 lds
    s_waitcnt vmcnt(6)
    v_mov_b32 v255, 27
    s_mov_b64 exec, 1
    ds_write_b32 v88, v255 offset:16
    s_mov_b64 exec, -1
    s_add_u32 m0, s61, 0
    s_add_u32 s53, s63, 0
    buffer_load_dwordx4 v240, s[4:7], s53 offen offset:0 sc1 lds
    buffer_load_dwordx4 v240, s[4:7], s53 offen offset:1024 sc1 lds
    s_add_u32 m0, s61, 16384
    s_add_u32 s53, s63, 114688
    buffer_load_dwordx4 v240, s[4:7], s53 offen offset:0 sc1 lds
    buffer_load_dwordx4 v240, s[4:7], s53 offen offset:1024 sc1 lds
    s_add_u32 m0, s61, 32768
    s_add_u32 s53, s63, 229376
    buffer_load_dwordx4 v240, s[4:7], s53 offen offset:0 sc1 lds
    buffer_load_dwordx4 v240, s[4:7], s53 offen offset:1024 sc1 lds
    s_add_u32 m0, s61, 49152
    s_add_u32 s53, s63, 344064
    buffer_load_dwordx4 v240, s[4:7], s53 offen offset:0 sc1 lds
    buffer_load_dwordx4 v240, s[4:7], s53 offen offset:1024 sc1 lds
    s_waitcnt vmcnt(19)
    s_mov_b32 s54, 20000
pl_23:
    v_cmp_ne_u32 vcc, 1, v222
    s_cbranch_vccz ok_24
    s_sub_u32 s54, s54, 1
    s_cbranch_scc1 ok_24
    buffer_load_dword v222, v247, s[4:7], s100 offen sc1
    s_waitcnt vmcnt(0)
    v_mov_b32 v255, 31
    s_mov_b64 exec, 1
    ds_write_b32 v88, v255 offset:16
    s_mov_b64 exec, -1
    s_branch pl_23
ok_24:
    s_add_u32 m0, s94, 135168
    s_nop 0
    buffer_load_dwordx4 v254, s[4:7], s98 offen offset:0 sc1 lds
    buffer_load_dwordx4 v254, s[4:7], s98 offen offset:1024 sc1 lds
    s_add_u32 m0, s94, 137216
    s_nop 0
    buffer_load_dwordx4 v254, s[4:7], s99 offen offset:0 sc1 lds
    buffer_load_dwordx4 v254, s[4:7], s99 offen offset:1024 sc1 lds
    s_waitcnt vmcnt(12)
    v_mov_b32 v255, 28
    s_mov_b64 exec, 1
    ds_write_b32 v88, v255 offset:16
    s_mov_b64 exec, -1
    s_waitcnt vmcnt(10)
    v_mov_b32 v255, 29
    s_mov_b64 exec, 1
    ds_write_b32 v88, v255 offset:16
    s_mov_b64 exec, -1
    s_waitcnt vmcnt(8)
    v_mov_b32 v255, 30
    s_mov_b64 exec, 1
    ds_write_b32 v88, v255 offset:16
    s_mov_b64 exec, -1
    s_waitcnt vmcnt(6)
    v_mov_b32 v255, 31
    s_mov_b64 exec, 1
    ds_write_b32 v88, v255 offset:16
    s_mov_b64 exec, -1
    s_waitcnt vmcnt(4)
    v_mov_b32 v255, 32
    s_mov_b64 exec, 1
    ds_write_b32 v88, v255 offset:16
    s_mov_b64 exec, -1
    s_waitcnt vmcnt(0)
    v_mov_b32 v255, 60
    s_mov_b64 exec, 1
    ds_write_b32 v88, v255 offset:16
    s_mov_b64 exec, -1
    s_waitcnt lgkmcnt(0)
    s_endpgm
sl_27:
    s_mov_b32 s54, 1000000
sp_28:
    ds_read_b32 v91, v90 offset:0
    s_waitcnt lgkmcnt(0)
    v_cmp_gt_u32 vcc, 5, v91
    s_cbranch_vccz bk_29
    s_sub_u32 s54, s54, 1
    s_cbranch_scc0 sp_28
    s_branch bk_29
yrole_2:
    v_and_b32 v20, 255, v0
    v_and_b32 v0, 63, v0
    s_lshl_b32 s46, s37, 11
    v_lshlrev_b32 v17, 4, v0
    s_add_u32 s47, s46, 2097152
    v_lshlrev_b32 v232, 10, v0
    v_mov_b32 v233, 0
    s_lshl_b32 s56, s35, 2
    s_add_u32 s56, s56, 42598400
    s_lshl_b32 s45, s35, 2
    s_add_u32 s45, s45, 42213376
    s_waitcnt lgkmcnt(0)
    s_mov_b32 s8, s64
    s_mov_b32 s9, s65
    s_mov_b32 s10, 4194304
    s_mov_b32 s11, 0x20000
    s_mov_b32 s4, s84
    s_mov_b32 s5, s85
    s_mov_b32 s6, 268435456
    s_mov_b32 s7, 0x20000
    s_cmp_lg_u32 s3, 0
    s_cbranch_scc1 sk_31
    s_mov_b64 exec, 255
    buffer_store_dword v233, v232, s[4:7], s56 offen sc1
    s_mov_b64 exec, 1
    buffer_store_dword v233, off, s[4:7], s45 sc1
    s_mov_b64 exec, -1
sk_31:
    buffer_load_dwordx4 v[216:219], v17, s[8:11], s46 offen offset:0
    buffer_load_dwordx4 v[220:223], v17, s[8:11], s46 offen offset:1024
    buffer_load_dwordx4 v[224:227], v17, s[8:11], s47 offen offset:0
    buffer_load_dwordx4 v[228:231], v17, s[8:11], s47 offen offset:1024
    s_lshl_b32 s97, s32, 1
    s_add_u32 s97, s97, s34
    s_lshl_b32 s97, s97, 7
    s_add_u32 s97, s97, 42336256
    s_lshl_b32 s46, s33, 2
    s_add_u32 s46, s46, s3
    s_lshl_b32 s46, s46, 2
    s_add_u32 s46, s46, s97
    s_lshl_b32 s47, s3, 8
    s_add_u32 s47, s47, s35
    s_lshl_b32 s47, s47, 2
    s_add_u32 s47, s47, 42598400
    s_lshl_b32 s56, s37, 2
    s_add_u32 s56, s56, 42467328
    s_mov_b64 exec, 1
    v_mov_b32 v28, 0
    buffer_store_dword v28, off, s[4:7], s46 sc1
    buffer_store_dword v28, off, s[4:7], s56 sc1
    s_mov_b64 exec, -1
    s_getpc_b64 s[50:51]
pc_ref:
    s_lshr_b32 s52, s2, 3
    s_sub_u32 s50, s50, pc_ref-parallel_sum__spectral_gfnet__dense_activation_gelu__prompt_kernel
    s_subb_u32 s51, s51, 0
    s_lshl_b32 s52, s52, 2
    s_add_u32 s52, s52, s3
    s_mul_i32 s52, s52, 512
    v_lshl_add_u32 v254, v0, 6, s52
    v_min_u32 v254, code_end-parallel_sum__spectral_gfnet__dense_activation_gelu__prompt_kernel-4, v254
    s_mov_b64 exec, 0xff
    global_load_dword v255, v254, s[50:51]
    s_mov_b64 exec, -1
    s_mov_b32 s16, s72
    s_mov_b32 s17, s73
    s_mov_b32 s18, 7340032
    s_mov_b32 s19, 0x20000
    s_mov_b32 s12, s76
    s_mov_b32 s13, s77
    s_mov_b32 s14, 7340032
    s_mov_b32 s15, 0x20000
    s_mov_b32 s20, s74
    s_mov_b32 s21, s75
    s_mov_b32 s22, 7168
    s_mov_b32 s23, 0x20000
    s_mov_b32 s24, s80
    s_mov_b32 s25, s81
    s_mov_b32 s26, 4194304
    s_mov_b32 s27, 0x20000
    s_mov_b32 s28, s82
    s_mov_b32 s29, s83
    s_mov_b32 s30, 256
    s_mov_b32 s31, 0x20000
    s_mov_b32 s60, s66
    s_mov_b32 s61, s67
    s_mov_b32 s62, 2101248
    s_mov_b32 s63, 0x20000
    s_mov_b32 s88, s68
    s_mov_b32 s89, s69
    s_mov_b32 s90, 2101248
    s_mov_b32 s91, 0x20000
    v_and_b32 v1, 31, v0
    v_lshrrev_b32 v19, 5, v0
    v_cvt_f32_u32 v170, v19
    v_cvt_f32_u32 v21, s37
    v_lshrrev_b32 v40, 1, v1
    v_and_b32 v41, 1, v1
    v_cvt_f32_u32 v168, v40
    v_cvt_f32_u32 v169, v41
    v_mul_f32 v21, 0x3a000000, v21
    v_mul_f32 v168, 0x3d000000, v168
    v_fmamk_f32 v169, v169, 0x3e800000, v21
    v_mul_f32 v170, 4.0, v170
    v_fmac_f32 v169, v170, v168
    v_lshlrev_b32 v40, 4, v40
    v_lshl_add_u32 v40, v19, 9, v40
    v_lshl_add_u32 v40, v41, 12, v40
    v_add_u32 v40, 152576, v40
    v_add_u32 v41, 135168, v17
    v_mov_b32 v172, v169
    v_fmamk_f32 v173, v168, 0x3f800000, v169
    v_fmamk_f32 v174, v168, 0x40000000, v169
    v_fmamk_f32 v175, v168, 0x40400000, v169
    v_cos_f32 v176, v172
    v_sin_f32 v180, v172
    v_cos_f32 v177, v173
    v_sin_f32 v181, v173
    v_cos_f32 v178, v174
    v_sin_f32 v182, v174
    v_cos_f32 v179, v175
    v_sin_f32 v183, v175
    v_cvt_pk_bf16_f32 v120, v176, v180
    v_cvt_pk_bf16_f32 v121, v177, v181
    v_cvt_pk_bf16_f32 v122, v178, v182
    v_cvt_pk_bf16_f32 v123, v179, v183
    v_fmamk_f32 v172, v168, 0x41000000, v169
    v_fmamk_f32 v173, v168, 0x41100000, v169
    v_fmamk_f32 v174, v168, 0x41200000, v169
    v_fmamk_f32 v175, v168, 0x41300000, v169
    v_cos_f32 v176, v172
    v_sin_f32 v180, v172
    v_cos_f32 v177, v173
    v_sin_f32 v181, v173
    v_cos_f32 v178, v174
    v_sin_f32 v182, v174
    v_cos_f32 v179, v175
    v_sin_f32 v183, v175
    v_cvt_pk_bf16_f32 v124, v176, v180
    v_cvt_pk_bf16_f32 v125, v177, v181
    v_cvt_pk_bf16_f32 v126, v178, v182
    v_cvt_pk_bf16_f32 v127, v179, v183
    v_fmamk_f32 v172, v168, 0x41800000, v169
    v_fmamk_f32 v173, v168, 0x41880000, v169
    v_fmamk_f32 v174, v168, 0x41900000, v169
    v_fmamk_f32 v175, v168, 0x41980000, v169
    v_cos_f32 v176, v172
    v_sin_f32 v180, v172
    v_cos_f32 v177, v173
    v_sin_f32 v181, v173
    v_cos_f32 v178, v174
    v_sin_f32 v182, v174
    v_cos_f32 v179, v175
    v_sin_f32 v183, v175
    v_cvt_pk_bf16_f32 v128, v176, v180
    v_cvt_pk_bf16_f32 v129, v177, v181
    v_cvt_pk_bf16_f32 v130, v178, v182
    v_cvt_pk_bf16_f32 v131, v179, v183
    v_fmamk_f32 v172, v168, 0x41c00000, v169
    v_fmamk_f32 v173, v168, 0x41c80000, v169
    v_fmamk_f32 v174, v168, 0x41d00000, v169
    v_fmamk_f32 v175, v168, 0x41d80000, v169
    v_cos_f32 v176, v172
    v_sin_f32 v180, v172
    v_cos_f32 v177, v173
    v_sin_f32 v181, v173
    v_cos_f32 v178, v174
    v_sin_f32 v182, v174
    v_cos_f32 v179, v175
    v_sin_f32 v183, v175
    v_cvt_pk_bf16_f32 v132, v176, v180
    v_cvt_pk_bf16_f32 v133, v177, v181
    v_cvt_pk_bf16_f32 v134, v178, v182
    v_cvt_pk_bf16_f32 v135, v179, v183
    s_lshl_b32 s94, s3, 12
    s_bfe_u32 s50, s35, 0x20002
    v_xor_b32 v24, s50, v20
    v_bfe_u32 v28, v24, 1, 1
    v_and_b32 v29, 1, v24
    v_bfe_u32 v30, v24, 2, 5
    v_lshrrev_b32 v31, 7, v24
    v_mul_u32_u24 v32, 513, v28
    v_lshl_add_u32 v30, v29, 5, v30
    v_lshl_add_u32 v30, v31, 6, v30
    v_add_u32 v29, v30, v32
    v_lshrrev_b32 v31, 2, v29
    v_and_b32 v31, 8, v31
    v_lshl_or_b32 v31, v28, 4, v31
    v_xor_b32 v29, v29, v31
    v_add_u32 v32, 528, v32
    v_cmp_eq_u32 vcc, 0, v30
    s_mov_b32 s50, 135168
    v_lshl_add_u32 v23, v29, 2, s50
    v_cndmask_b32 v29, v29, v32, vcc
    v_lshl_add_u32 v24, v24, 2, s50
    v_lshl_add_u32 v22, v29, 2, s50
    v_lshlrev_b32 v20, 4, v20
    v_bfe_u32 v28, v0, 2, 2
    v_lshl_add_u32 v28, v19, 3, v28
    v_lshlrev_b32 v18, 6, v28
    v_bfe_u32 v28, v0, 4, 1
    v_lshl_add_u32 v18, v28, 5, v18
    v_and_b32 v28, 3, v0
    v_lshl_add_u32 v18, v28, 3, v18
    s_mul_i32 s50, s3, 4352
    s_add_u32 s50, s50, 135168
    v_add_u32 v18, s50, v18
    v_add_u32 v39, s50, v17
    v_bfe_u32 v28, v0, 2, 1
    v_xor_b32 v28, v28, v0
    v_lshl_add_u32 v36, v28, 5, s50
    v_lshrrev_b32 v28, 4, v0
    v_bfe_u32 v29, v0, 2, 2
    v_lshl_add_u32 v29, v28, 3, v29
    v_mul_u32_u24 v29, 448, v29
    v_and_b32 v30, 3, v0
    v_lshl_add_u32 v29, v30, 3, v29
    s_lshr_b32 s50, s2, 6
    s_lshl_b32 s50, s50, 2
    s_add_u32 s50, s50, s3
    v_and_b32 v28, 1, v28
    v_xor_b32 v28, s50, v28
    v_lshl_add_u32 v25, v28, 5, v29
    s_lshl_b32 s51, s36, 4
    s_and_b32 s52, s32, 12
    s_add_u32 s51, s51, s52
    s_lshl_b32 s51, s51, 2
    s_add_u32 s51, s51, s50
    s_lshl_b32 s51, s51, 6
    s_add_u32 s100, s51, 41943040
    s_mul_i32 s57, s37, 2052
    s_waitcnt vmcnt(3)
    v_lshlrev_b32 v56, 16, v216
    v_and_b32 v57, 0xffff0000, v216
    v_lshlrev_b32 v58, 16, v217
    v_and_b32 v59, 0xffff0000, v217
    v_lshlrev_b32 v60, 16, v218
    v_and_b32 v61, 0xffff0000, v218
    v_lshlrev_b32 v62, 16, v219
    v_and_b32 v63, 0xffff0000, v219
    v_lshlrev_b32 v64, 16, v220
    v_and_b32 v65, 0xffff0000, v220
    v_lshlrev_b32 v66, 16, v221
    v_and_b32 v67, 0xffff0000, v221
    v_lshlrev_b32 v68, 16, v222
    v_and_b32 v69, 0xffff0000, v222
    v_lshlrev_b32 v70, 16, v223
    v_and_b32 v71, 0xffff0000, v223
    v_lshlrev_b32 v72, 16, v224
    v_and_b32 v73, 0xffff0000, v224
    v_lshlrev_b32 v74, 16, v225
    v_and_b32 v75, 0xffff0000, v225
    v_lshlrev_b32 v76, 16, v226
    v_and_b32 v77, 0xffff0000, v226
    v_lshlrev_b32 v78, 16, v227
    v_and_b32 v79, 0xffff0000, v227
    v_lshlrev_b32 v80, 16, v228
    v_and_b32 v81, 0xffff0000, v228
    v_lshlrev_b32 v82, 16, v229
    v_and_b32 v83, 0xffff0000, v229
    v_lshlrev_b32 v84, 16, v230
    v_and_b32 v85, 0xffff0000, v230
    v_lshlrev_b32 v86, 16, v231
    v_and_b32 v87, 0xffff0000, v231
    v_pk_add_f32 v[168:169], v[56:57], v[58:59]
    v_pk_add_f32 v[170:171], v[60:61], v[62:63]
    v_pk_add_f32 v[172:173], v[64:65], v[66:67]
    v_pk_add_f32 v[174:175], v[68:69], v[70:71]
    v_pk_add_f32 v[176:177], v[72:73], v[74:75]
    v_pk_add_f32 v[178:179], v[76:77], v[78:79]
    v_pk_add_f32 v[180:181], v[80:81], v[82:83]
    v_pk_add_f32 v[182:183], v[84:85], v[86:87]
    v_pk_add_f32 v[168:169], v[168:169], v[170:171]
    v_pk_add_f32 v[172:173], v[172:173], v[174:175]
    v_pk_add_f32 v[176:177], v[176:177], v[178:179]
    v_pk_add_f32 v[180:181], v[180:181], v[182:183]
    v_pk_add_f32 v[168:169], v[168:169], v[172:173]
    v_pk_add_f32 v[176:177], v[176:177], v[180:181]
    v_add_f32 v28, v168, v169
    v_sub_f32 v29, v168, v169
    v_add_f32 v30, v176, v177
    v_sub_f32 v31, v176, v177
    v_permlane16_swap_b32 v28, v29
    s_nop 0
    v_permlane16_swap_b32 v30, v31
    v_add_f32 v28, v28, v29
    v_add_f32 v30, v30, v31
    s_nop 1
    v_permlane32_swap_b32 v28, v30
    v_add_f32 v28, v28, v30
    s_nop 1
    v_add_f32_dpp v28, v28, v28 row_ror:8 row_mask:0xf bank_mask:0xf
    s_nop 1
    v_add_f32_dpp v28, v28, v28 row_ror:4 row_mask:0xf bank_mask:0xf
    s_nop 1
    v_add_f32_dpp v28, v28, v28 row_ror:2 row_mask:0xf bank_mask:0xf
    s_nop 1
    v_add_f32_dpp v28, v28, v28 row_ror:1 row_mask:0xf bank_mask:0xf
    v_mul_f32 v29, 0x3a800000, v28
    v_mov_b32 v30, v29
    v_cvt_pk_bf16_f32 v30, v30, v30
    v_and_b32 v30, 0xffff0000, v30
    v_sub_f32 v31, v29, v30
    v_readlane_b32 s96, v30, 0
    v_readlane_b32 s98, v30, 32
    v_readlane_b32 s92, v28, 16
    v_readlane_b32 s93, v28, 48
    v_pk_add_f32 v[56:57], v[56:57], s[96:97] op_sel_hi:[1,0] neg_lo:[0,1] neg_hi:[0,1]
    v_pk_add_f32 v[58:59], v[58:59], s[96:97] op_sel_hi:[1,0] neg_lo:[0,1] neg_hi:[0,1]
    v_pk_add_f32 v[60:61], v[60:61], s[96:97] op_sel_hi:[1,0] neg_lo:[0,1] neg_hi:[0,1]
    v_pk_add_f32 v[62:63], v[62:63], s[96:97] op_sel_hi:[1,0] neg_lo:[0,1] neg_hi:[0,1]
    v_pk_add_f32 v[64:65], v[64:65], s[96:97] op_sel_hi:[1,0] neg_lo:[0,1] neg_hi:[0,1]
    v_pk_add_f32 v[66:67], v[66:67], s[96:97] op_sel_hi:[1,0] neg_lo:[0,1] neg_hi:[0,1]
    v_pk_add_f32 v[68:69], v[68:69], s[96:97] op_sel_hi:[1,0] neg_lo:[0,1] neg_hi:[0,1]
    v_pk_add_f32 v[70:71], v[70:71], s[96:97] op_sel_hi:[1,0] neg_lo:[0,1] neg_hi:[0,1]
    v_pk_add_f32 v[72:73], v[72:73], s[98:99] op_sel_hi:[1,0] neg_lo:[0,1] neg_hi:[0,1]
    v_pk_add_f32 v[74:75], v[74:75], s[98:99] op_sel_hi:[1,0] neg_lo:[0,1] neg_hi:[0,1]
    v_pk_add_f32 v[76:77], v[76:77], s[98:99] op_sel_hi:[1,0] neg_lo:[0,1] neg_hi:[0,1]
    v_pk_add_f32 v[78:79], v[78:79], s[98:99] op_sel_hi:[1,0] neg_lo:[0,1] neg_hi:[0,1]
    v_pk_add_f32 v[80:81], v[80:81], s[98:99] op_sel_hi:[1,0] neg_lo:[0,1] neg_hi:[0,1]
    v_pk_add_f32 v[82:83], v[82:83], s[98:99] op_sel_hi:[1,0] neg_lo:[0,1] neg_hi:[0,1]
    v_pk_add_f32 v[84:85], v[84:85], s[98:99] op_sel_hi:[1,0] neg_lo:[0,1] neg_hi:[0,1]
    v_pk_add_f32 v[86:87], v[86:87], s[98:99] op_sel_hi:[1,0] neg_lo:[0,1] neg_hi:[0,1]
    v_pk_mul_f32 v[168:169], v[56:57], v[56:57]
    v_pk_mul_f32 v[170:171], v[58:59], v[58:59]
    v_pk_mul_f32 v[172:173], v[72:73], v[72:73]
    v_pk_mul_f32 v[174:175], v[74:75], v[74:75]
    v_pk_fma_f32 v[168:169], v[60:61], v[60:61], v[168:169]
    v_pk_fma_f32 v[170:171], v[62:63], v[62:63], v[170:171]
    v_pk_fma_f32 v[172:173], v[76:77], v[76:77], v[172:173]
    v_pk_fma_f32 v[174:175], v[78:79], v[78:79], v[174:175]
    v_pk_fma_f32 v[168:169], v[64:65], v[64:65], v[168:169]
    v_pk_fma_f32 v[170:171], v[66:67], v[66:67], v[170:171]
    v_pk_fma_f32 v[172:173], v[80:81], v[80:81], v[172:173]
    v_pk_fma_f32 v[174:175], v[82:83], v[82:83], v[174:175]
    v_pk_fma_f32 v[168:169], v[68:69], v[68:69], v[168:169]
    v_pk_fma_f32 v[170:171], v[70:71], v[70:71], v[170:171]
    v_pk_fma_f32 v[172:173], v[84:85], v[84:85], v[172:173]
    v_pk_fma_f32 v[174:175], v[86:87], v[86:87], v[174:175]
    v_pk_add_f32 v[168:169], v[168:169], v[170:171]
    v_pk_add_f32 v[172:173], v[172:173], v[174:175]
    v_add_f32 v32, v168, v169
    v_add_f32 v33, v172, v173
    s_nop 1
    v_permlane32_swap_b32 v32, v33
    v_add_f32 v32, v32, v33
    v_mov_b32 v33, v32
    s_nop 1
    v_permlane16_swap_b32 v32, v33
    v_add_f32 v32, v32, v33
    s_nop 1
    v_add_f32_dpp v32, v32, v32 row_ror:8 row_mask:0xf bank_mask:0xf
    s_nop 1
    v_add_f32_dpp v32, v32, v32 row_ror:4 row_mask:0xf bank_mask:0xf
    s_nop 1
    v_add_f32_dpp v32, v32, v32 row_ror:2 row_mask:0xf bank_mask:0xf
    s_nop 1
    v_add_f32_dpp v32, v32, v32 row_ror:1 row_mask:0xf bank_mask:0xf
    v_mul_f32 v32, 0x3a800000, v32
    v_fma_f32 v32, -v31, v31, v32
    v_max_f32 v32, 0, v32
    v_cvt_pk_bf16_f32 v32, v32, v32
    v_and_b32 v32, 0xffff0000, v32
    v_add_f32 v32, 0x3727c5ac, v32
    v_cvt_pk_bf16_f32 v32, v32, v32
    v_and_b32 v32, 0xffff0000, v32
    v_sqrt_f32 v32, v32
    s_nop 0
    v_cvt_pk_bf16_f32 v32, v32, v32
    v_and_b32 v32, 0xffff0000, v32
    v_cvt_pk_bf16_f32 v33, -v30, v32
    v_rcp_f32 v32, v32
    v_lshlrev_b32 v34, 12, v19
    s_lshl_b32 s50, s37, 2
    s_add_u32 s101, s50, 42205184
    v_readlane_b32 s96, v32, 0
    v_readlane_b32 s98, v32, 32
    s_mov_b32 exec_lo, 1
    s_mov_b32 exec_hi, 1
    buffer_store_dword v33, v34, s[4:7], s101 offen sc1
    s_mov_b64 exec, -1
    s_cmp_lg_u32 s3, 0
    s_cbranch_scc1 sk_32
    s_mov_b64 exec, 1
    s_and_b32 s50, s2, 63
    s_lshl_b32 s50, s50, 2
    v_mov_b32_e64 v35, 1
    buffer_atomic_add v35, off, s[28:31], s50 sc1
    s_mov_b64 exec, -1
sk_32:
    v_pk_mul_f32 v[56:57], v[56:57], s[96:97] op_sel_hi:[1,0]
    v_pk_mul_f32 v[58:59], v[58:59], s[96:97] op_sel_hi:[1,0]
    v_pk_mul_f32 v[60:61], v[60:61], s[96:97] op_sel_hi:[1,0]
    v_pk_mul_f32 v[62:63], v[62:63], s[96:97] op_sel_hi:[1,0]
    v_pk_mul_f32 v[64:65], v[64:65], s[96:97] op_sel_hi:[1,0]
    v_pk_mul_f32 v[66:67], v[66:67], s[96:97] op_sel_hi:[1,0]
    v_pk_mul_f32 v[68:69], v[68:69], s[96:97] op_sel_hi:[1,0]
    v_pk_mul_f32 v[70:71], v[70:71], s[96:97] op_sel_hi:[1,0]
    v_pk_fma_f32 v[168:169], v[72:73], s[98:99], v[56:57] op_sel_hi:[1,0,1]
    v_pk_fma_f32 v[184:185], v[72:73], s[98:99], v[56:57] op_sel_hi:[1,0,1] neg_lo:[1,0,0] neg_hi:[1,0,0]
    v_pk_fma_f32 v[170:171], v[74:75], s[98:99], v[58:59] op_sel_hi:[1,0,1]
    v_pk_fma_f32 v[186:187], v[74:75], s[98:99], v[58:59] op_sel_hi:[1,0,1] neg_lo:[1,0,0] neg_hi:[1,0,0]
    v_pk_fma_f32 v[172:173], v[76:77], s[98:99], v[60:61] op_sel_hi:[1,0,1]
    v_pk_fma_f32 v[188:189], v[76:77], s[98:99], v[60:61] op_sel_hi:[1,0,1] neg_lo:[1,0,0] neg_hi:[1,0,0]
    v_pk_fma_f32 v[174:175], v[78:79], s[98:99], v[62:63] op_sel_hi:[1,0,1]
    v_pk_fma_f32 v[190:191], v[78:79], s[98:99], v[62:63] op_sel_hi:[1,0,1] neg_lo:[1,0,0] neg_hi:[1,0,0]
    v_pk_fma_f32 v[176:177], v[80:81], s[98:99], v[64:65] op_sel_hi:[1,0,1]
    v_pk_fma_f32 v[192:193], v[80:81], s[98:99], v[64:65] op_sel_hi:[1,0,1] neg_lo:[1,0,0] neg_hi:[1,0,0]
    v_pk_fma_f32 v[178:179], v[82:83], s[98:99], v[66:67] op_sel_hi:[1,0,1]
    v_pk_fma_f32 v[194:195], v[82:83], s[98:99], v[66:67] op_sel_hi:[1,0,1] neg_lo:[1,0,0] neg_hi:[1,0,0]
    v_pk_fma_f32 v[180:181], v[84:85], s[98:99], v[68:69] op_sel_hi:[1,0,1]
    v_pk_fma_f32 v[196:197], v[84:85], s[98:99], v[68:69] op_sel_hi:[1,0,1] neg_lo:[1,0,0] neg_hi:[1,0,0]
    v_pk_fma_f32 v[182:183], v[86:87], s[98:99], v[70:71] op_sel_hi:[1,0,1]
    v_pk_fma_f32 v[198:199], v[86:87], s[98:99], v[70:71] op_sel_hi:[1,0,1] neg_lo:[1,0,0] neg_hi:[1,0,0]
    s_waitcnt lgkmcnt(0)
    s_barrier
    ds_read_b128 v[88:91], v41 offset:8192
    ds_read_b128 v[92:95], v41 offset:9216
    ds_read_b128 v[96:99], v41 offset:10240
    ds_read_b128 v[100:103], v41 offset:11264
    ds_read_b128 v[136:139], v41 offset:0
    ds_read_b128 v[140:143], v41 offset:1024
    ds_read_b128 v[144:147], v41 offset:2048
    ds_read_b128 v[148:151], v41 offset:3072
    ds_read_b128 v[152:155], v41 offset:4096
    ds_read_b128 v[156:159], v41 offset:5120
    ds_read_b128 v[160:163], v41 offset:6144
    ds_read_b128 v[164:167], v41 offset:7168
    ds_read_b128 v[104:107], v40 offset:0
    ds_read_b128 v[108:111], v40 offset:1024
    ds_read_b128 v[112:115], v40 offset:2048
    ds_read_b128 v[116:119], v40 offset:3072
    v_cvt_pk_bf16_f32 v200, v168, v169
    v_cvt_pk_bf16_f32 v201, v170, v171
    v_cvt_pk_bf16_f32 v202, v172, v173
    v_cvt_pk_bf16_f32 v203, v174, v175
    v_cvt_pk_bf16_f32 v204, v176, v177
    v_cvt_pk_bf16_f32 v205, v178, v179
    v_cvt_pk_bf16_f32 v206, v180, v181
    v_cvt_pk_bf16_f32 v207, v182, v183
    v_cvt_pk_bf16_f32 v208, v184, v185
    v_cvt_pk_bf16_f32 v209, v186, v187
    v_cvt_pk_bf16_f32 v210, v188, v189
    v_cvt_pk_bf16_f32 v211, v190, v191
    v_cvt_pk_bf16_f32 v212, v192, v193
    v_cvt_pk_bf16_f32 v213, v194, v195
    v_cvt_pk_bf16_f32 v214, v196, v197
    v_cvt_pk_bf16_f32 v215, v198, v199
    s_waitcnt lgkmcnt(0)
    s_barrier
    ds_write_b128 v39, v[200:203] offset:0
    ds_write_b128 v39, v[204:207] offset:1024
    ds_write_b128 v39, v[208:211] offset:2048
    ds_write_b128 v39, v[212:215] offset:3072
    v_mov_b32 v28, s96
    v_mov_b32 v29, s98
    v_mul_f32 v28, s92, v28
    v_mul_f32 v29, s93, v29
    v_cos_f32 v30, v21
    v_sin_f32 v31, v21
    v_add_f32 v32, v28, v29
    v_sub_f32 v33, v28, v29
    v_mul_f32 v32, 0.5, v32
    v_mul_f32 v33, 0.5, v33
    v_mul_f32_e64 v30, v30, v33
    v_mul_f32_e64 v31, v31, v33
    v_cvt_pk_bf16_f32 v37, v32, 0
    v_cvt_pk_bf16_f32 v38, v30, -v31
    s_waitcnt lgkmcnt(0)
    ds_read_b64_tr_b16 v[56:57], v18 offset:0
    ds_read_b64_tr_b16 v[58:59], v18 offset:256
    ds_read_b64_tr_b16 v[60:61], v18 offset:1024
    ds_read_b64_tr_b16 v[62:63], v18 offset:1280
    ds_read_b64_tr_b16 v[64:65], v18 offset:2048
    ds_read_b64_tr_b16 v[66:67], v18 offset:2304
    ds_read_b64_tr_b16 v[68:69], v18 offset:3072
    ds_read_b64_tr_b16 v[70:71], v18 offset:3328
    s_waitcnt lgkmcnt(0)
    s_setprio 3
    v_mfma_f32_32x32x16_bf16 v[168:183], v[56:59], v[88:91], 0
    v_mfma_f32_32x32x16_bf16 v[184:199], v[56:59], v[96:99], 0
    v_mfma_f32_32x32x16_bf16 v[168:183], v[60:63], v[92:95], v[168:183]
    v_mfma_f32_32x32x16_bf16 v[184:199], v[60:63], v[100:103], v[184:199]
    v_mfma_f32_32x32x16_bf16 v[200:215], v[64:67], v[88:91], 0
    v_mfma_f32_32x32x16_bf16 v[216:231], v[64:67], v[96:99], 0
    v_mfma_f32_32x32x16_bf16 v[200:215], v[68:71], v[92:95], v[200:215]
    v_mfma_f32_32x32x16_bf16 v[216:231], v[68:71], v[100:103], v[216:231]
    s_setprio 0
    s_nop 5
    v_pk_mul_f32 v[28:29], v[168:169], v[136:137]
    v_pk_mul_f32 v[30:31], v[184:185], v[136:137]
    v_pk_mul_f32 v[32:33], v[170:171], v[138:139]
    v_pk_mul_f32 v[34:35], v[186:187], v[138:139]
    v_pk_fma_f32 v[28:29], v[184:185], v[152:153], v[28:29]
    v_pk_fma_f32 v[30:31], v[168:169], v[152:153], v[30:31] neg_lo:[1,0,0] neg_hi:[1,0,0]
    v_pk_fma_f32 v[32:33], v[186:187], v[154:155], v[32:33]
    v_pk_fma_f32 v[34:35], v[170:171], v[154:155], v[34:35] neg_lo:[1,0,0] neg_hi:[1,0,0]
    v_cvt_pk_bf16_f32 v40, v28, v30
    v_cvt_pk_bf16_f32 v41, v29, v31
    v_cvt_pk_bf16_f32 v42, v32, v34
    v_cvt_pk_bf16_f32 v43, v33, v35
    v_pk_mul_f32 v[28:29], v[172:173], v[140:141]
    v_pk_mul_f32 v[30:31], v[188:189], v[140:141]
    v_pk_mul_f32 v[32:33], v[174:175], v[142:143]
    v_pk_mul_f32 v[34:35], v[190:191], v[142:143]
    v_pk_fma_f32 v[28:29], v[188:189], v[156:157], v[28:29]
    v_pk_fma_f32 v[30:31], v[172:173], v[156:157], v[30:31] neg_lo:[1,0,0] neg_hi:[1,0,0]
    v_pk_fma_f32 v[32:33], v[190:191], v[158:159], v[32:33]
    v_pk_fma_f32 v[34:35], v[174:175], v[158:159], v[34:35] neg_lo:[1,0,0] neg_hi:[1,0,0]
    v_cvt_pk_bf16_f32 v44, v28, v30
    v_cvt_pk_bf16_f32 v45, v29, v31
    v_cvt_pk_bf16_f32 v46, v32, v34
    v_cvt_pk_bf16_f32 v47, v33, v35
    v_pk_mul_f32 v[28:29], v[176:177], v[144:145]
    v_pk_mul_f32 v[30:31], v[192:193], v[144:145]
    v_pk_mul_f32 v[32:33], v[178:179], v[146:147]
    v_pk_mul_f32 v[34:35], v[194:195], v[146:147]
    v_pk_fma_f32 v[28:29], v[192:193], v[160:161], v[28:29]
    v_pk_fma_f32 v[30:31], v[176:177], v[160:161], v[30:31] neg_lo:[1,0,0] neg_hi:[1,0,0]
    v_pk_fma_f32 v[32:33], v[194:195], v[162:163], v[32:33]
    v_pk_fma_f32 v[34:35], v[178:179], v[162:163], v[34:35] neg_lo:[1,0,0] neg_hi:[1,0,0]
    v_cvt_pk_bf16_f32 v48, v28, v30
    v_cvt_pk_bf16_f32 v49, v29, v31
    v_cvt_pk_bf16_f32 v50, v32, v34
    v_cvt_pk_bf16_f32 v51, v33, v35
    v_pk_mul_f32 v[28:29], v[180:181], v[148:149]
    v_pk_mul_f32 v[30:31], v[196:197], v[148:149]
    v_pk_mul_f32 v[32:33], v[182:183], v[150:151]
    v_pk_mul_f32 v[34:35], v[198:199], v[150:151]
    v_pk_fma_f32 v[28:29], v[196:197], v[164:165], v[28:29]
    v_pk_fma_f32 v[30:31], v[180:181], v[164:165], v[30:31] neg_lo:[1,0,0] neg_hi:[1,0,0]
    v_pk_fma_f32 v[32:33], v[198:199], v[166:167], v[32:33]
    v_pk_fma_f32 v[34:35], v[182:183], v[166:167], v[34:35] neg_lo:[1,0,0] neg_hi:[1,0,0]
    v_cvt_pk_bf16_f32 v52, v28, v30
    v_cvt_pk_bf16_f32 v53, v29, v31
    v_cvt_pk_bf16_f32 v54, v32, v34
    v_cvt_pk_bf16_f32 v55, v33, v35
    s_barrier
    buffer_load_dwordx4 v[240:243], v17, s[88:91], s57 offen offset:0
    buffer_load_dwordx4 v[232:235], v17, s[60:63], s57 offen offset:0
    v_add_u32 v25, 106496, v25
    ds_read_b64_tr_b16 v[72:73], v25 offset:0
    ds_read_b64_tr_b16 v[74:75], v25 offset:1792
    ds_read_b64_tr_b16 v[76:77], v25 offset:14336
    ds_read_b64_tr_b16 v[78:79], v25 offset:16128
    v_mov_b32 v84, 0x3f803f80
    v_mov_b32 v85, 0x3f803f80
    v_mov_b32 v86, 0x3f803f80
    v_mov_b32 v87, 0x3f803f80
    s_setprio 3
    v_mfma_f32_32x32x16_bf16 v[168:183], v[104:107], v[40:43], 0
    v_mfma_f32_32x32x16_bf16 v[168:183], v[108:111], v[44:47], v[168:183]
    v_mfma_f32_32x32x16_bf16 v[168:183], v[112:115], v[48:51], v[168:183]
    v_mfma_f32_32x32x16_bf16 v[168:183], v[116:119], v[52:55], v[168:183]
    s_setprio 0
    v_pk_mul_f32 v[28:29], v[200:201], v[136:137]
    v_pk_mul_f32 v[30:31], v[216:217], v[136:137]
    v_pk_mul_f32 v[32:33], v[202:203], v[138:139]
    v_pk_mul_f32 v[34:35], v[218:219], v[138:139]
    v_pk_fma_f32 v[28:29], v[216:217], v[152:153], v[28:29]
    v_pk_fma_f32 v[30:31], v[200:201], v[152:153], v[30:31] neg_lo:[1,0,0] neg_hi:[1,0,0]
    v_pk_fma_f32 v[32:33], v[218:219], v[154:155], v[32:33]
    v_pk_fma_f32 v[34:35], v[202:203], v[154:155], v[34:35] neg_lo:[1,0,0] neg_hi:[1,0,0]
    v_cvt_pk_bf16_f32 v88, v28, v30
    v_cvt_pk_bf16_f32 v89, v29, v31
    v_cvt_pk_bf16_f32 v90, v32, v34
    v_cvt_pk_bf16_f32 v91, v33, v35
    v_pk_mul_f32 v[28:29], v[204:205], v[140:141]
    v_pk_mul_f32 v[30:31], v[220:221], v[140:141]
    v_pk_mul_f32 v[32:33], v[206:207], v[142:143]
    v_pk_mul_f32 v[34:35], v[222:223], v[142:143]
    v_pk_fma_f32 v[28:29], v[220:221], v[156:157], v[28:29]
    v_pk_fma_f32 v[30:31], v[204:205], v[156:157], v[30:31] neg_lo:[1,0,0] neg_hi:[1,0,0]
    v_pk_fma_f32 v[32:33], v[222:223], v[158:159], v[32:33]
    v_pk_fma_f32 v[34:35], v[206:207], v[158:159], v[34:35] neg_lo:[1,0,0] neg_hi:[1,0,0]
    v_cvt_pk_bf16_f32 v92, v28, v30
    v_cvt_pk_bf16_f32 v93, v29, v31
    v_cvt_pk_bf16_f32 v94, v32, v34
    v_cvt_pk_bf16_f32 v95, v33, v35
    v_pk_mul_f32 v[28:29], v[208:209], v[144:145]
    v_pk_mul_f32 v[30:31], v[224:225], v[144:145]
    v_pk_mul_f32 v[32:33], v[210:211], v[146:147]
    v_pk_mul_f32 v[34:35], v[226:227], v[146:147]
    v_pk_fma_f32 v[28:29], v[224:225], v[160:161], v[28:29]
    v_pk_fma_f32 v[30:31], v[208:209], v[160:161], v[30:31] neg_lo:[1,0,0] neg_hi:[1,0,0]
    v_pk_fma_f32 v[32:33], v[226:227], v[162:163], v[32:33]
    v_pk_fma_f32 v[34:35], v[210:211], v[162:163], v[34:35] neg_lo:[1,0,0] neg_hi:[1,0,0]
    v_cvt_pk_bf16_f32 v96, v28, v30
    v_cvt_pk_bf16_f32 v97, v29, v31
    v_cvt_pk_bf16_f32 v98, v32, v34
    v_cvt_pk_bf16_f32 v99, v33, v35
    v_pk_mul_f32 v[28:29], v[212:213], v[148:149]
    v_pk_mul_f32 v[30:31], v[228:229], v[148:149]
    v_pk_mul_f32 v[32:33], v[214:215], v[150:151]
    v_pk_mul_f32 v[34:35], v[230:231], v[150:151]
    v_pk_fma_f32 v[28:29], v[228:229], v[164:165], v[28:29]
    v_pk_fma_f32 v[30:31], v[212:213], v[164:165], v[30:31] neg_lo:[1,0,0] neg_hi:[1,0,0]
    v_pk_fma_f32 v[32:33], v[230:231], v[166:167], v[32:33]
    v_pk_fma_f32 v[34:35], v[214:215], v[166:167], v[34:35] neg_lo:[1,0,0] neg_hi:[1,0,0]
    v_cvt_pk_bf16_f32 v100, v28, v30
    v_cvt_pk_bf16_f32 v101, v29, v31
    v_cvt_pk_bf16_f32 v102, v32, v34
    v_cvt_pk_bf16_f32 v103, v33, v35
    s_setprio 3
    v_mfma_f32_32x32x16_bf16 v[200:215], v[120:123], v[88:91], 0
    v_mfma_f32_32x32x16_bf16 v[200:215], v[124:127], v[92:95], v[200:215]
    v_mfma_f32_32x32x16_bf16 v[200:215], v[128:131], v[96:99], v[200:215]
    v_mfma_f32_32x32x16_bf16 v[200:215], v[132:135], v[100:103], v[200:215]
    s_setprio 0
    v_cvt_pk_bf16_f32 v56, v168, v169
    v_cvt_pk_bf16_f32 v57, v170, v171
    v_cvt_pk_bf16_f32 v60, v172, v173
    v_cvt_pk_bf16_f32 v61, v174, v175
    v_cvt_pk_bf16_f32 v64, v176, v177
    v_cvt_pk_bf16_f32 v65, v178, v179
    v_cvt_pk_bf16_f32 v68, v180, v181
    v_cvt_pk_bf16_f32 v69, v182, v183
    s_nop 2
    v_cvt_pk_bf16_f32 v58, v200, v201
    v_cvt_pk_bf16_f32 v59, v202, v203
    v_cvt_pk_bf16_f32 v62, v204, v205
    v_cvt_pk_bf16_f32 v63, v206, v207
    v_cvt_pk_bf16_f32 v66, v208, v209
    v_cvt_pk_bf16_f32 v67, v210, v211
    v_cvt_pk_bf16_f32 v70, v212, v213
    v_cvt_pk_bf16_f32 v71, v214, v215
    s_waitcnt lgkmcnt(0)
    s_setprio 3
    v_mfma_f32_16x16x32_bf16 v[80:83], v[84:87], v[72:75], 0
    v_mfma_f32_16x16x32_bf16 v[80:83], v[84:87], v[76:79], v[80:83]
    s_setprio 0
    s_barrier
    buffer_load_dwordx4 v[244:247], v17, s[88:91], s57 offen offset:1024
    buffer_load_dwordx4 v[236:239], v17, s[60:63], s57 offen offset:1024
    v_add_u32 v25, 4294877184, v25
    ds_read_b64_tr_b16 v[72:73], v25 offset:0
    ds_read_b64_tr_b16 v[74:75], v25 offset:1792
    ds_read_b64_tr_b16 v[76:77], v25 offset:14336
    ds_read_b64_tr_b16 v[78:79], v25 offset:16128
    s_mov_b64 exec, 1
    v_mov_b32_e64 v56, v37
    v_mov_b32_e64 v58, v38
    s_mov_b64 exec, -1
    ds_write_b128 v39, v[56:59] offset:0
    ds_write_b128 v39, v[60:63] offset:1024
    ds_write_b128 v39, v[64:67] offset:2048
    ds_write_b128 v39, v[68:71] offset:3072
    s_waitcnt lgkmcnt(0)
    s_waitcnt lgkmcnt(0)
    s_setprio 3
    v_mfma_f32_16x16x32_bf16 v[80:83], v[84:87], v[72:75], v[80:83]
    v_mfma_f32_16x16x32_bf16 v[80:83], v[84:87], v[76:79], v[80:83]
    s_setprio 0
    s_barrier
    buffer_load_dword v249, off, s[88:91], s57 offset:2048
    buffer_load_dword v248, off, s[60:63], s57 offset:2048
    v_add_u32 v25, 45056, v25
    ds_read_b64_tr_b16 v[72:73], v25 offset:0
    ds_read_b64_tr_b16 v[74:75], v25 offset:1792
    ds_read_b64_tr_b16 v[76:77], v25 offset:14336
    ds_read_b64_tr_b16 v[78:79], v25 offset:16128
    ds_read2st64_b32 v[168:169], v24 offset0:0 offset1:17
    ds_read2st64_b32 v[170:171], v24 offset0:34 offset1:51
    ds_read2st64_b32 v[172:173], v24 offset0:4 offset1:21
    ds_read2st64_b32 v[174:175], v24 offset0:38 offset1:55
    ds_read2st64_b32 v[176:177], v24 offset0:8 offset1:25
    ds_read2st64_b32 v[178:179], v24 offset0:42 offset1:59
    ds_read2st64_b32 v[180:181], v24 offset0:12 offset1:29
    ds_read2st64_b32 v[182:183], v24 offset0:46 offset1:63
    s_mul_i32 s99, s35, 16640
    s_add_u32 s99, s99, 16777216
    s_waitcnt lgkmcnt(0)
    s_mov_b32 s52, 0x05040100
    s_mov_b32 s53, 0x07060302
    v_xor_b32_e64 v29, 64, v36
    s_waitcnt vmcnt(0)
    v_perm_b32 v40, v240, v232, s52
    v_perm_b32 v41, v240, v232, s53
    v_perm_b32 v42, v241, v233, s52
    v_perm_b32 v43, v241, v233, s53
    v_perm_b32 v44, v242, v234, s52
    v_perm_b32 v45, v242, v234, s53
    v_perm_b32 v46, v243, v235, s52
    v_perm_b32 v47, v243, v235, s53
    v_perm_b32 v48, v244, v236, s52
    v_perm_b32 v49, v244, v236, s53
    v_perm_b32 v50, v245, v237, s52
    v_perm_b32 v51, v245, v237, s53
    v_perm_b32 v52, v246, v238, s52
    v_perm_b32 v53, v246, v238, s53
    v_perm_b32 v54, v247, v239, s52
    v_perm_b32 v55, v247, v239, s53
    v_perm_b32 v250, v249, v248, s52
    v_perm_b32 v251, v249, v248, s53
    s_waitcnt lgkmcnt(0)
    s_setprio 3
    v_mfma_f32_16x16x32_bf16 v[80:83], v[84:87], v[72:75], v[80:83]
    v_mfma_f32_16x16x32_bf16 v[80:83], v[84:87], v[76:79], v[80:83]
    s_setprio 0
    v_or_b32_e64 v168, 1, v168
    v_or_b32_e64 v170, 1, v170
    buffer_store_dwordx4 v[168:171], v20, s[4:7], s99 offen sc1
    s_add_u32 s99, s99, 4096
    v_or_b32 v172, 1, v172
    v_or_b32 v174, 1, v174
    buffer_store_dwordx4 v[172:175], v20, s[4:7], s99 offen sc1
    s_add_u32 s99, s99, 4096
    v_or_b32 v176, 1, v176
    v_or_b32 v178, 1, v178
    buffer_store_dwordx4 v[176:179], v20, s[4:7], s99 offen sc1
    s_add_u32 s99, s99, 4096
    v_or_b32_e64 v180, 1, v180
    v_or_b32_e64 v182, 1, v182
    buffer_store_dwordx4 v[180:183], v20, s[4:7], s99 offen sc1
    s_barrier
    v_add_u32 v25, 45056, v25
    ds_read_b64_tr_b16 v[72:73], v25 offset:0
    ds_read_b64_tr_b16 v[74:75], v25 offset:1792
    ds_read_b64_tr_b16 v[76:77], v25 offset:14336
    ds_read_b64_tr_b16 v[78:79], v25 offset:16128
    ds_write_b128 v36, v[40:43] offset:0
    ds_write_b128 v36, v[44:47] offset:16
    ds_write_b128 v29, v[48:51] offset:2048
    ds_write_b128 v29, v[52:55] offset:2064
    s_mov_b64 exec, 1
    ds_write_b64 v36, v[250:251] offset:4160
    s_mov_b64 exec, -1
    s_waitcnt lgkmcnt(0)
    s_waitcnt lgkmcnt(0)
    s_setprio 3
    v_mfma_f32_16x16x32_bf16 v[80:83], v[84:87], v[72:75], v[80:83]
    v_mfma_f32_16x16x32_bf16 v[80:83], v[84:87], v[76:79], v[80:83]
    s_setprio 0
    v_add_u32 v28, 152576, v17
    ds_read_b128 v[88:91], v28 offset:0
    ds_read_b128 v[92:95], v28 offset:1024
    ds_read_b128 v[96:99], v28 offset:2048
    ds_read_b128 v[100:103], v28 offset:3072
    ds_read_b128 v[104:107], v28 offset:4096
    ds_read_b128 v[108:111], v28 offset:5120
    ds_read_b128 v[112:115], v28 offset:6144
    ds_read_b128 v[116:119], v28 offset:7168
    s_waitcnt vmcnt(0)
    s_mov_b64 exec, 1
    v_mov_b32 v12, 1
    buffer_store_dword v12, off, s[4:7], s47 sc1
    s_mov_b64 exec, -1
    s_barrier
    v_lshlrev_b32_e64 v81, 2, v0
    s_mov_b64 exec, 0xffff
    buffer_store_dword v80, v81, s[4:7], s100 offen sc1
    s_mov_b64 exec, -1
    ds_read2st64_b32 v[232:233], v22 offset0:0 offset1:17
    ds_read2st64_b32 v[234:235], v22 offset0:34 offset1:51
    ds_read2st64_b32 v[236:237], v23 offset0:2 offset1:19
    ds_read2st64_b32 v[238:239], v23 offset0:36 offset1:53
    ds_read2st64_b32 v[240:241], v23 offset0:4 offset1:21
    ds_read2st64_b32 v[242:243], v23 offset0:38 offset1:55
    ds_read2st64_b32 v[244:245], v23 offset0:6 offset1:23
    ds_read2st64_b32 v[246:247], v23 offset0:40 offset1:57
    s_mul_i32 s98, s35, 16640
    s_add_u32 s98, s98, 22020096
    s_waitcnt lgkmcnt(0)
    buffer_store_dwordx4 v[232:235], v20, s[4:7], s98 offen sc1
    s_add_u32 s98, s98, 4096
    buffer_store_dwordx4 v[236:239], v20, s[4:7], s98 offen sc1
    s_add_u32 s98, s98, 4096
    buffer_store_dwordx4 v[240:243], v20, s[4:7], s98 offen sc1
    s_add_u32 s98, s98, 4096
    buffer_store_dwordx4 v[244:247], v20, s[4:7], s98 offen sc1
    v_lshlrev_b32 v18, 2, v0
    s_bfe_u32 s56, s35, 0x20004
    s_lshl_b32 s56, s56, 2
    s_add_u32 s56, s56, s3
    s_lshl_b32 s56, s56, 8
    s_add_u32 s56, s56, 42598400
    buffer_load_dword v22, v18, s[28:31], 0 offen sc1
    s_barrier
    s_and_b32 s43, s3, 1
    s_lshr_b32 s44, s3, 1
    v_lshrrev_b32 v6, 2, v0
    v_and_b32 v7, 7, v6
    v_and_b32 v8, 3, v0
    v_lshlrev_b32 v8, 3, v8
    v_lshl_add_u32 v8, v6, 8, v8
    v_add_u32 v8, 65536, v8
    s_lshl_b32 s40, s43, 2
    v_xor_b32 v7, s40, v7
    v_xor_b32 v9, 0, v7
    v_lshl_add_u32 v2, v9, 5, v8
    v_xor_b32 v9, 1, v7
    v_lshl_add_u32 v3, v9, 5, v8
    v_xor_b32 v9, 2, v7
    v_lshl_add_u32 v4, v9, 5, v8
    v_xor_b32 v9, 3, v7
    v_lshl_add_u32 v5, v9, 5, v8
    s_lshl_b32 s40, s44, 12
    s_lshl_b32 s41, s34, 11
    s_add_u32 s42, s40, s41
    v_add_u32 v6, s42, v17
    s_xor_b32 s42, s42, 2048
    v_add_u32 v7, s42, v17
    v_and_b32 v11, 15, v0
    v_bfe_u32 v12, v0, 4, 1
    v_lshlrev_b32 v8, 11, v11
    v_lshl_add_u32 v8, v12, 5, v8
    v_lshl_add_u32 v8, v19, 4, v8
    v_lshrrev_b32 v10, 2, v11
    v_xor_b32 v10, v10, v19
    v_lshlrev_b32 v9, 6, v11
    v_lshl_add_u32 v9, v10, 4, v9
    v_lshl_add_u32 v9, v12, 3, v9
    s_add_u32 s40, s94, 135168
    v_add_u32 v9, s40, v9
    v_xor_b32 v10, 32, v9
    s_lshl_b32 s41, s3, 2
    s_add_u32 s41, s41, 163328
    v_mov_b32 v11, s41
    s_mul_i32 s57, s35, 16640
    s_xor_b32 s41, s35, 8
    s_mul_i32 s41, s41, 16640
    s_add_u32 s42, s94, 16777216
    s_add_u32 s57, s57, s42
    s_add_u32 s41, s41, s42
    s_lshl_b32 s42, s44, 1
    s_add_u32 s42, s42, s34
    s_lshl_b32 s40, s32, 2
    s_add_u32 s42, s42, s40
    s_lshl_b32 s42, s42, 16
    s_lshl_b32 s40, s33, 8
    s_add_u32 s42, s42, s40
    s_lshl_b32 s40, s43, 7
    s_add_u32 s42, s42, s40
    s_mov_b32 s40, s57
    s_mov_b32 s46, 5
    v_lshrrev_b32 v28, 3, v20
    s_mul_i32 s50, s36, 448
    buffer_load_ushort v214, v28, s[20:23], s50 offen
    v_lshrrev_b32 v25, 1, v20
    v_add_u32 v25, 160768, v25
    v_lshrrev_b32 v28, 4, v0
    v_bfe_u32 v29, v0, 1, 3
    v_and_b32 v30, 1, v0
    v_lshlrev_b32 v30, 4, v30
    v_add_u32 v13, 0, v28
    v_and_b32 v31, 7, v13
    v_xor_b32 v31, v31, v29
    v_lshl_add_u32 v31, v31, 5, v30
    v_lshl_add_u32 v13, v13, 11, v31
    v_add_u32 v14, 4, v28
    v_and_b32 v31, 7, v14
    v_xor_b32 v31, v31, v29
    v_lshl_add_u32 v31, v31, 5, v30
    v_lshl_add_u32 v14, v14, 11, v31
    v_subrev_u32 v14, 1024, v14
    v_add_u32 v15, 8, v28
    v_and_b32 v31, 7, v15
    v_xor_b32 v31, v31, v29
    v_lshl_add_u32 v31, v31, 5, v30
    v_lshl_add_u32 v15, v15, 11, v31
    v_subrev_u32 v15, 2048, v15
    v_add_u32 v16, 12, v28
    v_and_b32 v31, 7, v16
    v_xor_b32 v31, v31, v29
    v_lshl_add_u32 v31, v31, 5, v30
    v_lshl_add_u32 v16, v16, 11, v31
    v_subrev_u32 v16, 3072, v16
    s_lshl_b32 s94, s3, 12
    s_lshl_b32 s50, s32, 1
    s_add_u32 s50, s50, s34
    s_mul_i32 s50, s50, 458752
    s_lshr_b32 s51, s3, 1
    s_and_b32 s52, s3, 1
    s_lshl_b32 s53, s52, 12
    s_add_u32 s50, s50, s53
    s_mul_i32 s48, s51, 8192
    s_add_u32 s48, s48, s50
    s_mul_i32 s92, s51, 57344
    s_add_u32 s92, s92, s50
    s_add_u32 s92, s92, 49152
    s_mul_i32 s50, s34, 3670016
    s_lshl_b32 s53, s33, 8
    s_add_u32 s50, s50, s53
    s_lshl_b32 s49, s51, 18
    s_add_u32 s49, s49, s50
    s_lshl_b32 s53, s52, 15
    s_add_u32 s49, s49, s53
    s_mul_i32 s93, s51, 458752
    s_add_u32 s93, s93, s50
    s_lshl_b32 s53, s52, 14
    s_add_u32 s93, s93, s53
    s_add_u32 s93, s93, 196608
    v_lshrrev_b32 v23, 2, v0
    v_mul_u32_u24 v23, 16640, v23
    v_and_b32 v28, 3, v0
    v_lshl_add_u32 v23, v28, 4, v23
    v_bfe_u32 v36, v0, 2, 2
    v_xor_b32 v36, s3, v36
    v_lshlrev_b32 v36, 4, v36
    v_lshl_add_u32 v24, v0, 6, v36
    v_add_u32 v36, 135168, v24
    s_waitcnt vmcnt(2)
    s_waitcnt vmcnt(1)
    s_mov_b32 s54, 20000
pl_33:
    v_and_b32 v28, 255, v22
    v_cmp_gt_u32 vcc, 4, v28
    s_cbranch_vccz ok_34
    s_sub_u32 s54, s54, 1
    s_cbranch_scc1 ok_34
    buffer_load_dword v22, v18, s[28:31], 0 offen sc1
    s_waitcnt vmcnt(0)
    s_branch pl_33
ok_34:
    s_barrier
    s_cmp_lg_u32 s3, 0
    s_cbranch_scc1 sk_35
    s_mov_b64 exec, 1
    v_mov_b32 v12, 2
    buffer_store_dword v12, off, s[4:7], s45 sc1
    s_mov_b64 exec, -1
sk_35:
    s_barrier
    s_barrier
    v_lshlrev_b32 v215, 2, v0
    buffer_load_dword v22, v215, s[4:7], s56 offen sc1
    s_barrier
    s_waitcnt vmcnt(0)
    s_mov_b32 s54, 20000
pl_36:
    v_cmp_gt_u32 vcc, 1, v22
    s_cbranch_vccz ok_37
    s_sub_u32 s54, s54, 1
    s_cbranch_scc1 ok_37
    buffer_load_dword v22, v215, s[4:7], s56 offen sc1
    s_waitcnt vmcnt(0)
    s_branch pl_36
ok_37:
    s_mul_i32 s55, s3, 1064960
    s_lshl_b32 s52, s35, 6-zz0
    s_add_u32 s55, s55, s52
    s_add_u32 s55, s55, 16777216
    s_add_u32 m0, s94, 135168
    s_nop 0
    buffer_load_dwordx4 v23, s[4:7], s55 offen sc1 lds
    s_add_u32 m0, s94, 136192
    s_add_u32 s55, s55, 266240
    buffer_load_dwordx4 v23, s[4:7], s55 offen sc1 lds
    s_add_u32 m0, s94, 137216
    s_add_u32 s55, s55, 266240
    buffer_load_dwordx4 v23, s[4:7], s55 offen sc1 lds
    s_add_u32 m0, s94, 138240
    s_add_u32 s55, s55, 266240
    buffer_load_dwordx4 v23, s[4:7], s55 offen sc1 lds
    s_mov_b32 s60, s78
    s_mov_b32 s61, s79
    s_mov_b32 s62, 2048
    s_mov_b32 s63, 0x20000
    v_and_b32 v28, 63, v8
    s_and_b32 s50, s42, 2047
    buffer_load_dwordx4 v[248:251], v28, s[60:63], s50 offen offset:0
    buffer_load_dwordx4 v[252:255], v28, s[60:63], s50 offen offset:64
    s_barrier
    s_mov_b32 s56, 42213376
    buffer_load_dwordx4 v[208:211], v17, s[4:7], s56 offen sc1
    s_waitcnt vmcnt(3)
    s_barrier
    ds_read_b128 v[40:43], v36 offset:0
    ds_read_b128 v[44:47], v36 offset:4096
    ds_read_b128 v[48:51], v36 offset:8192
    ds_read_b128 v[52:55], v36 offset:12288
    s_waitcnt vmcnt(0)
    s_mov_b32 s54, 20000
pl_38:
    v_min3_u32 v208, v208, v209, v210
    v_min_u32 v208, v208, v211
    v_cmp_gt_u32 vcc, 2, v208
    s_cbranch_vccz ok_39
    s_sub_u32 s54, s54, 1
    s_cbranch_scc1 ok_39
    buffer_load_dwordx4 v[208:211], v17, s[4:7], s56 offen sc1
    s_waitcnt vmcnt(0)
    s_branch pl_38
ok_39:
    s_and_b32 s50, s3, 1
    s_lshl_b32 s50, s50, 8
    s_add_u32 m0, s50, 162816
    s_lshl_b32 s51, s32, 9
    s_add_u32 s50, s50, s51
    s_add_u32 s50, s50, 42205184
    buffer_load_dword v18, s[4:7], s50 offen sc1 lds
    s_lshl_b32 s50, s36, 12
    s_lshl_b32 s51, s3, 8
    s_add_u32 s50, s50, s51
    s_add_u32 s50, s50, 41943040
    buffer_load_dword v208, v18, s[4:7], s50 offen offset:0 sc1
    buffer_load_dword v209, v18, s[4:7], s50 offen offset:1024 sc1
    buffer_load_dword v210, v18, s[4:7], s50 offen offset:2048 sc1
    buffer_load_dword v211, v18, s[4:7], s50 offen offset:3072 sc1
    s_waitcnt vmcnt(6)
    v_permlane16_swap_b32 v248, v250
    v_permlane16_swap_b32 v249, v251
    v_permlane16_swap_b32 v252, v254
    v_permlane16_swap_b32 v253, v255
    v_lshlrev_b32 v216, 16, v248
    v_and_b32 v217, 0xffff0000, v248
    v_lshlrev_b32 v218, 16, v249
    v_and_b32 v219, 0xffff0000, v249
    v_lshlrev_b32 v220, 16, v250
    v_and_b32 v221, 0xffff0000, v250
    v_lshlrev_b32 v222, 16, v251
    v_and_b32 v223, 0xffff0000, v251
    v_lshlrev_b32 v224, 16, v252
    v_and_b32 v225, 0xffff0000, v252
    v_lshlrev_b32 v226, 16, v253
    v_and_b32 v227, 0xffff0000, v253
    v_lshlrev_b32 v228, 16, v254
    v_and_b32 v229, 0xffff0000, v254
    v_lshlrev_b32 v230, 16, v255
    v_and_b32 v231, 0xffff0000, v255
    s_waitcnt lgkmcnt(0)
    s_setprio 3
    v_mfma_f32_32x32x16_bf16 v[168:183], v[40:43], v[88:91], 0
    v_mfma_f32_32x32x16_bf16 v[184:199], v[40:43], v[104:107], 0
    v_mfma_f32_32x32x16_bf16 v[168:183], v[44:47], v[92:95], v[168:183]
    v_mfma_f32_32x32x16_bf16 v[184:199], v[44:47], v[108:111], v[184:199]
    v_mfma_f32_32x32x16_bf16 v[168:183], v[48:51], v[96:99], v[168:183]
    v_mfma_f32_32x32x16_bf16 v[184:199], v[48:51], v[112:115], v[184:199]
    v_mfma_f32_32x32x16_bf16 v[168:183], v[52:55], v[100:103], v[168:183]
    v_mfma_f32_32x32x16_bf16 v[184:199], v[52:55], v[116:119], v[184:199]
    s_setprio 0
    s_barrier
    s_mul_i32 s55, s3, 1064960
    s_lshl_b32 s52, s35, 6-zz0
    s_add_u32 s55, s55, s52
    s_add_u32 s55, s55, 22020096
    s_add_u32 m0, s94, 49152
    s_nop 0
    buffer_load_dwordx4 v23, s[4:7], s55 offen sc1 lds
    s_add_u32 m0, s94, 50176
    s_add_u32 s55, s55, 266240
    buffer_load_dwordx4 v23, s[4:7], s55 offen sc1 lds
    s_add_u32 m0, s94, 51200
    s_add_u32 s55, s55, 266240
    buffer_load_dwordx4 v23, s[4:7], s55 offen sc1 lds
    s_add_u32 m0, s94, 52224
    s_add_u32 s55, s55, 266240
    buffer_load_dwordx4 v23, s[4:7], s55 offen sc1 lds
    s_add_u32 m0, s94, 65536
    s_add_u32 s95, s33, 0
    s_and_b32 s95, s95, 7
    s_mul_i32 s96, s95, 458752
    s_mul_i32 s95, s95, 57344
    s_add_u32 s96, s96, s49
    s_add_u32 s95, s95, s48
    buffer_load_dwordx4 v13, s[12:15], s96 offen offset:0 lds
    buffer_load_dwordx4 v14, s[12:15], s96 offen offset:1024 lds
    buffer_load_dwordx4 v15, s[12:15], s96 offen offset:2048 lds
    buffer_load_dwordx4 v16, s[12:15], s96 offen offset:3072 lds
    v_mov_b32 v12, 0
    ds_write_b32 v11, v12
    ds_write_b32 v11, v12 offset:16
    ds_write_b32 v11, v12 offset:32
    ds_write_b32 v11, v12 offset:48
    s_waitcnt vmcnt(8)
    v_add_f32 v208, v208, v209
    v_add_f32 v210, v210, v211
    s_mov_b32 s101, 0x07060302
    v_add_f32 v208, v208, v210
    v_and_b32 v209, 0xffff0000, v208
    v_sub_f32 v209, v208, v209
    v_and_b32 v210, 0xffff0000, v209
    v_perm_b32 v212, v209, v208, s101
    v_sub_f32_e64 v210, v209, v210
    v_alignbit_b32 v213, v214, v210, 16
    ds_write_b64 v25, v[212:213]
    v_pk_mul_f32 v[28:29], v[168:169], v[136:137]
    v_pk_mul_f32 v[30:31], v[184:185], v[136:137]
    v_pk_mul_f32 v[32:33], v[170:171], v[138:139]
    v_pk_mul_f32 v[34:35], v[186:187], v[138:139]
    v_pk_fma_f32 v[28:29], v[184:185], v[152:153], v[28:29]
    v_pk_fma_f32 v[30:31], v[168:169], v[152:153], v[30:31] neg_lo:[1,0,0] neg_hi:[1,0,0]
    v_pk_fma_f32 v[32:33], v[186:187], v[154:155], v[32:33]
    v_pk_fma_f32 v[34:35], v[170:171], v[154:155], v[34:35] neg_lo:[1,0,0] neg_hi:[1,0,0]
    v_cvt_pk_bf16_f32 v40, v28, v30
    v_cvt_pk_bf16_f32 v41, v29, v31
    v_cvt_pk_bf16_f32 v42, v32, v34
    v_cvt_pk_bf16_f32 v43, v33, v35
    v_pk_mul_f32 v[28:29], v[172:173], v[140:141]
    v_pk_mul_f32 v[30:31], v[188:189], v[140:141]
    v_pk_mul_f32 v[32:33], v[174:175], v[142:143]
    v_pk_mul_f32 v[34:35], v[190:191], v[142:143]
    v_pk_fma_f32 v[28:29], v[188:189], v[156:157], v[28:29]
    v_pk_fma_f32 v[30:31], v[172:173], v[156:157], v[30:31] neg_lo:[1,0,0] neg_hi:[1,0,0]
    v_pk_fma_f32 v[32:33], v[190:191], v[158:159], v[32:33]
    v_pk_fma_f32 v[34:35], v[174:175], v[158:159], v[34:35] neg_lo:[1,0,0] neg_hi:[1,0,0]
    v_cvt_pk_bf16_f32 v44, v28, v30
    v_cvt_pk_bf16_f32 v45, v29, v31
    v_cvt_pk_bf16_f32 v46, v32, v34
    v_cvt_pk_bf16_f32 v47, v33, v35
    v_pk_mul_f32 v[28:29], v[176:177], v[144:145]
    v_pk_mul_f32 v[30:31], v[192:193], v[144:145]
    v_pk_mul_f32 v[32:33], v[178:179], v[146:147]
    v_pk_mul_f32 v[34:35], v[194:195], v[146:147]
    v_pk_fma_f32 v[28:29], v[192:193], v[160:161], v[28:29]
    v_pk_fma_f32 v[30:31], v[176:177], v[160:161], v[30:31] neg_lo:[1,0,0] neg_hi:[1,0,0]
    v_pk_fma_f32 v[32:33], v[194:195], v[162:163], v[32:33]
    v_pk_fma_f32 v[34:35], v[178:179], v[162:163], v[34:35] neg_lo:[1,0,0] neg_hi:[1,0,0]
    v_cvt_pk_bf16_f32 v48, v28, v30
    v_cvt_pk_bf16_f32 v49, v29, v31
    v_cvt_pk_bf16_f32 v50, v32, v34
    v_cvt_pk_bf16_f32 v51, v33, v35
    v_pk_mul_f32 v[28:29], v[180:181], v[148:149]
    v_pk_mul_f32 v[30:31], v[196:197], v[148:149]
    v_pk_mul_f32 v[32:33], v[182:183], v[150:151]
    v_pk_mul_f32 v[34:35], v[198:199], v[150:151]
    v_pk_fma_f32 v[28:29], v[196:197], v[164:165], v[28:29]
    v_pk_fma_f32 v[30:31], v[180:181], v[164:165], v[30:31] neg_lo:[1,0,0] neg_hi:[1,0,0]
    v_pk_fma_f32 v[32:33], v[198:199], v[166:167], v[32:33]
    v_pk_fma_f32 v[34:35], v[182:183], v[166:167], v[34:35] neg_lo:[1,0,0] neg_hi:[1,0,0]
    v_cvt_pk_bf16_f32 v52, v28, v30
    v_cvt_pk_bf16_f32 v53, v29, v31
    v_cvt_pk_bf16_f32 v54, v32, v34
    v_cvt_pk_bf16_f32 v55, v33, v35
    s_barrier
    s_add_u32 m0, s94, 81920
    s_add_u32 s95, s33, 0
    s_and_b32 s95, s95, 7-zz0
    s_mul_i32 s96, s95, 458752
    s_mul_i32 s95, s95, 57344
    s_add_u32 s96, s96, s49
    s_add_u32 s95, s95, s48
    s_add_u32 s96, s96, 65536
    s_add_u32 s95, s95, 16384
    buffer_load_dwordx4 v13, s[12:15], s96 offen offset:0 lds
    buffer_load_dwordx4 v14, s[12:15], s96 offen offset:1024 lds
    buffer_load_dwordx4 v15, s[12:15], s96 offen offset:2048 lds
    buffer_load_dwordx4 v16, s[12:15], s96 offen offset:3072 lds
    s_cmp_lg_u32 s3, 0
    s_cbranch_scc1 sk_42
    v_cvt_pk_f16_f32 v28, v136, v152
    v_cvt_pk_f16_f32 v29, v137, v153
    v_cvt_pk_f16_f32 v30, v138, v154
    v_cvt_pk_f16_f32 v31, v139, v155
sk_42:
    s_cmp_lg_u32 s3, 1
    s_cbranch_scc1 sk_43
    v_cvt_pk_f16_f32 v28, v140, v156
    v_cvt_pk_f16_f32 v29, v141, v157
    v_cvt_pk_f16_f32 v30, v142, v158
    v_cvt_pk_f16_f32 v31, v143, v159
sk_43:
    s_cmp_lg_u32 s3, 2
    s_cbranch_scc1 sk_44
    v_cvt_pk_f16_f32 v28, v144, v160
    v_cvt_pk_f16_f32 v29, v145, v161
    v_cvt_pk_f16_f32 v30, v146, v162
    v_cvt_pk_f16_f32 v31, v147, v163
sk_44:
    s_cmp_lg_u32 s3, 3
    s_cbranch_scc1 sk_45
    v_cvt_pk_f16_f32 v28, v148, v164
    v_cvt_pk_f16_f32 v29, v149, v165
    v_cvt_pk_f16_f32 v30, v150, v166
    v_cvt_pk_f16_f32 v31, v151, v167
sk_45:
    s_lshl_b32 s50, s3, 10
    s_add_u32 s50, s50, 131072
    v_add_u32 v32, s50, v17
    ds_write_b128 v32, v[28:31]
    s_add_u32 m0, s94, 98304
    s_add_u32 s95, s33, 0
    s_and_b32 s95, s95, 7
    s_mul_i32 s96, s95, 458752
    s_mul_i32 s95, s95, 57344
    s_add_u32 s96, s96, s49
    s_add_u32 s95, s95, s48
    s_add_u32 s96, s96, 131072
    s_add_u32 s95, s95, 32768
    buffer_load_dwordx4 v13, s[12:15], s96 offen offset:0 lds
    buffer_load_dwordx4 v14, s[12:15], s96 offen offset:1024 lds
    buffer_load_dwordx4 v15, s[12:15], s96 offen offset:2048 lds
    buffer_load_dwordx4 v16, s[12:15], s96 offen offset:3072 lds
    s_add_u32 m0, s94, 114688
    s_cmp_lt_u32 s33, 1-zz0
    s_cselect_b32 s95, 1, 0
    s_mul_i32 s96, s95, 458752
    s_mul_i32 s95, s95, 57344
    s_add_u32 s96, s96, s49
    s_add_u32 s95, s95, s48
    buffer_load_dwordx4 v13, s[12:15], s96 offen offset:0 lds
    buffer_load_dwordx4 v14, s[12:15], s96 offen offset:1024 lds
    buffer_load_dwordx4 v15, s[12:15], s96 offen offset:2048 lds
    buffer_load_dwordx4 v16, s[12:15], s96 offen offset:3072 lds
    v_lshlrev_b32 v37, 7, v0
    s_lshl_b32 s39, s2, 2
    s_add_u32 s39, s39, s3
    s_mul_i32 s39, s39, 7168
    buffer_load_dword v38, v37, s[12:15], s39 offen
    s_setprio 3
    v_mfma_f32_32x32x16_bf16 v[168:183], v[88:91], v[40:43], 0
    v_mfma_f32_32x32x16_bf16 v[184:199], v[104:107], v[40:43], 0
    v_mfma_f32_32x32x16_bf16 v[168:183], v[92:95], v[44:47], v[168:183]
    v_mfma_f32_32x32x16_bf16 v[184:199], v[108:111], v[44:47], v[184:199]
    v_mfma_f32_32x32x16_bf16 v[168:183], v[96:99], v[48:51], v[168:183]
    v_mfma_f32_32x32x16_bf16 v[184:199], v[112:115], v[48:51], v[184:199]
    v_mfma_f32_32x32x16_bf16 v[168:183], v[100:103], v[52:55], v[168:183]
    v_mfma_f32_32x32x16_bf16 v[184:199], v[116:119], v[52:55], v[184:199]
    s_setprio 0
    s_waitcnt vmcnt(17)
    s_waitcnt lgkmcnt(0)
    s_barrier
    ds_read_b128 v[120:123], v24 offset:49152
    ds_read_b128 v[124:127], v24 offset:53248
    ds_read_b128 v[128:131], v24 offset:57344
    ds_read_b128 v[132:135], v24 offset:61440
    s_waitcnt lgkmcnt(0)
    v_lshlrev_b32 v56, 16, v120
    v_and_b32 v72, 0xffff0000, v120
    v_lshlrev_b32 v57, 16, v121
    v_and_b32 v73, 0xffff0000, v121
    v_lshlrev_b32 v58, 16, v122
    v_and_b32 v74, 0xffff0000, v122
    v_lshlrev_b32 v59, 16, v123
    v_and_b32 v75, 0xffff0000, v123
    v_lshlrev_b32 v60, 16, v124
    v_and_b32 v76, 0xffff0000, v124
    v_lshlrev_b32 v61, 16, v125
    v_and_b32 v77, 0xffff0000, v125
    v_lshlrev_b32 v62, 16, v126
    v_and_b32 v78, 0xffff0000, v126
    v_lshlrev_b32 v63, 16, v127
    v_and_b32 v79, 0xffff0000, v127
    v_lshlrev_b32 v64, 16, v128
    v_and_b32 v80, 0xffff0000, v128
    v_lshlrev_b32 v65, 16, v129
    v_and_b32 v81, 0xffff0000, v129
    v_lshlrev_b32 v66, 16, v130
    v_and_b32 v82, 0xffff0000, v130
    v_lshlrev_b32 v67, 16, v131
    v_and_b32 v83, 0xffff0000, v131
    v_lshlrev_b32_e64 v68, 16, v132
    v_and_b32 v84, 0xffff0000, v132
    v_lshlrev_b32_e64 v69, 16, v133
    v_and_b32 v85, 0xffff0000, v133
    v_lshlrev_b32_e64 v70, 16, v134
    v_and_b32 v86, 0xffff0000, v134
    v_lshlrev_b32_e64 v71, 16, v135
    v_and_b32 v87, 0xffff0000, v135
    v_pk_mul_f32 v[28:29], v[168:169], v[56:57]
    v_pk_mul_f32 v[30:31], v[184:185], v[56:57]
    v_pk_mul_f32 v[32:33], v[170:171], v[58:59]
    v_pk_mul_f32 v[34:35], v[186:187], v[58:59]
    v_pk_fma_f32 v[28:29], v[184:185], v[72:73], v[28:29] neg_lo:[1,0,0] neg_hi:[1,0,0]
    v_pk_fma_f32 v[30:31], v[168:169], v[72:73], v[30:31]
    v_pk_fma_f32 v[32:33], v[186:187], v[74:75], v[32:33] neg_lo:[1,0,0] neg_hi:[1,0,0]
    v_pk_fma_f32 v[34:35], v[170:171], v[74:75], v[34:35]
    v_cvt_pk_bf16_f32 v120, v30, v28
    v_cvt_pk_bf16_f32 v121, v31, v29
    v_cvt_pk_bf16_f32 v122, v34, v32
    v_cvt_pk_bf16_f32 v123, v35, v33
    v_pk_mul_f32 v[28:29], v[172:173], v[60:61]
    v_pk_mul_f32 v[30:31], v[188:189], v[60:61]
    v_pk_mul_f32 v[32:33], v[174:175], v[62:63]
    v_pk_mul_f32 v[34:35], v[190:191], v[62:63]
    v_pk_fma_f32 v[28:29], v[188:189], v[76:77], v[28:29] neg_lo:[1,0,0] neg_hi:[1,0,0]
    v_pk_fma_f32 v[30:31], v[172:173], v[76:77], v[30:31]
    v_pk_fma_f32 v[32:33], v[190:191], v[78:79], v[32:33] neg_lo:[1,0,0] neg_hi:[1,0,0]
    v_pk_fma_f32 v[34:35], v[174:175], v[78:79], v[34:35]
    v_cvt_pk_bf16_f32 v124, v30, v28
    v_cvt_pk_bf16_f32 v125, v31, v29
    v_cvt_pk_bf16_f32 v126, v34, v32
    v_cvt_pk_bf16_f32 v127, v35, v33
    v_pk_mul_f32 v[28:29], v[176:177], v[64:65]
    v_pk_mul_f32 v[30:31], v[192:193], v[64:65]
    v_pk_mul_f32 v[32:33], v[178:179], v[66:67]
    v_pk_mul_f32 v[34:35], v[194:195], v[66:67]
    v_pk_fma_f32 v[28:29], v[192:193], v[80:81], v[28:29] neg_lo:[1,0,0] neg_hi:[1,0,0]
    v_pk_fma_f32 v[30:31], v[176:177], v[80:81], v[30:31]
    v_pk_fma_f32 v[32:33], v[194:195], v[82:83], v[32:33] neg_lo:[1,0,0] neg_hi:[1,0,0]
    v_pk_fma_f32 v[34:35], v[178:179], v[82:83], v[34:35]
    v_cvt_pk_bf16_f32 v128, v30, v28
    v_cvt_pk_bf16_f32 v129, v31, v29
    v_cvt_pk_bf16_f32 v130, v34, v32
    v_cvt_pk_bf16_f32 v131, v35, v33
    v_pk_mul_f32 v[28:29], v[180:181], v[68:69]
    v_pk_mul_f32 v[30:31], v[196:197], v[68:69]
    v_pk_mul_f32 v[32:33], v[182:183], v[70:71]
    v_pk_mul_f32 v[34:35], v[198:199], v[70:71]
    v_pk_fma_f32 v[28:29], v[196:197], v[84:85], v[28:29] neg_lo:[1,0,0] neg_hi:[1,0,0]
    v_pk_fma_f32 v[30:31], v[180:181], v[84:85], v[30:31]
    v_pk_fma_f32 v[32:33], v[198:199], v[86:87], v[32:33] neg_lo:[1,0,0] neg_hi:[1,0,0]
    v_pk_fma_f32 v[34:35], v[182:183], v[86:87], v[34:35]
    v_cvt_pk_bf16_f32 v132, v30, v28
    v_cvt_pk_bf16_f32 v133, v31, v29
    v_cvt_pk_bf16_f32 v134, v34, v32
    v_cvt_pk_bf16_f32 v135, v35, v33
    buffer_load_dwordx4 v[232:235], v8, s[8:11], s42 offen offset:0
    v_mfma_f32_32x32x16_bf16 v[184:199], v[120:123], v[88:91], 0
    v_mfma_f32_32x32x16_bf16 v[168:183], v[120:123], v[104:107], 0
    v_mfma_f32_32x32x16_bf16 v[184:199], v[124:127], v[92:95], v[184:199]
    v_mfma_f32_32x32x16_bf16 v[168:183], v[124:127], v[108:111], v[168:183]
    v_mfma_f32_32x32x16_bf16 v[184:199], v[128:131], v[96:99], v[184:199]
    v_mfma_f32_32x32x16_bf16 v[168:183], v[128:131], v[112:115], v[168:183]
    v_mfma_f32_32x32x16_bf16 v[184:199], v[132:135], v[100:103], v[184:199]
    v_mfma_f32_32x32x16_bf16 v[168:183], v[132:135], v[116:119], v[168:183]
    buffer_load_dwordx4 v[236:239], v8, s[8:11], s42 offen offset:64
    s_nop 10
    v_pk_mul_f32 v[28:29], v[168:169], v[136:137]
    v_pk_mul_f32 v[30:31], v[184:185], v[136:137]
    v_pk_mul_f32 v[32:33], v[170:171], v[138:139]
    v_pk_mul_f32 v[34:35], v[186:187], v[138:139]
    v_pk_fma_f32 v[28:29], v[184:185], v[152:153], v[28:29] neg_lo:[1,0,0] neg_hi:[1,0,0]
    v_pk_fma_f32 v[30:31], v[168:169], v[152:153], v[30:31]
    v_pk_fma_f32 v[32:33], v[186:187], v[154:155], v[32:33] neg_lo:[1,0,0] neg_hi:[1,0,0]
    v_pk_fma_f32 v[34:35], v[170:171], v[154:155], v[34:35]
    v_cvt_pk_bf16_f32 v40, v30, v28
    v_cvt_pk_bf16_f32 v41, v31, v29
    v_cvt_pk_bf16_f32 v42, v34, v32
    v_cvt_pk_bf16_f32 v43, v35, v33
    v_pk_mul_f32 v[28:29], v[172:173], v[140:141]
    v_pk_mul_f32 v[30:31], v[188:189], v[140:141]
    v_pk_mul_f32 v[32:33], v[174:175], v[142:143]
    v_pk_mul_f32 v[34:35], v[190:191], v[142:143]
    v_pk_fma_f32 v[28:29], v[188:189], v[156:157], v[28:29] neg_lo:[1,0,0] neg_hi:[1,0,0]
    v_pk_fma_f32 v[30:31], v[172:173], v[156:157], v[30:31]
    v_pk_fma_f32 v[32:33], v[190:191], v[158:159], v[32:33] neg_lo:[1,0,0] neg_hi:[1,0,0]
    v_pk_fma_f32 v[34:35], v[174:175], v[158:159], v[34:35]
    v_cvt_pk_bf16_f32 v44, v30, v28
    v_cvt_pk_bf16_f32 v45, v31, v29
    v_cvt_pk_bf16_f32 v46, v34, v32
    v_cvt_pk_bf16_f32 v47, v35, v33
    v_pk_mul_f32 v[28:29], v[176:177], v[144:145]
    v_pk_mul_f32 v[30:31], v[192:193], v[144:145]
    v_pk_mul_f32 v[32:33], v[178:179], v[146:147]
    v_pk_mul_f32 v[34:35], v[194:195], v[146:147]
    v_pk_fma_f32 v[28:29], v[192:193], v[160:161], v[28:29] neg_lo:[1,0,0] neg_hi:[1,0,0]
    v_pk_fma_f32 v[30:31], v[176:177], v[160:161], v[30:31]
    v_pk_fma_f32 v[32:33], v[194:195], v[162:163], v[32:33] neg_lo:[1,0,0] neg_hi:[1,0,0]
    v_pk_fma_f32 v[34:35], v[178:179], v[162:163], v[34:35]
    v_cvt_pk_bf16_f32 v48, v30, v28
    v_cvt_pk_bf16_f32 v49, v31, v29
    v_cvt_pk_bf16_f32 v50, v34, v32
    v_cvt_pk_bf16_f32 v51, v35, v33
    v_pk_mul_f32 v[28:29], v[180:181], v[148:149]
    v_pk_mul_f32 v[30:31], v[196:197], v[148:149]
    v_pk_mul_f32 v[32:33], v[182:183], v[150:151]
    v_pk_mul_f32 v[34:35], v[198:199], v[150:151]
    v_pk_fma_f32 v[28:29], v[196:197], v[164:165], v[28:29] neg_lo:[1,0,0] neg_hi:[1,0,0]
    v_pk_fma_f32 v[30:31], v[180:181], v[164:165], v[30:31]
    v_pk_fma_f32 v[32:33], v[198:199], v[166:167], v[32:33] neg_lo:[1,0,0] neg_hi:[1,0,0]
    v_pk_fma_f32 v[34:35], v[182:183], v[166:167], v[34:35]
    v_cvt_pk_bf16_f32 v52, v30, v28
    v_cvt_pk_bf16_f32 v53, v31, v29
    v_cvt_pk_bf16_f32 v54, v34, v32
    v_cvt_pk_bf16_f32 v55, v35, v33
    s_add_u32 s50, s42, 32768
    buffer_load_dwordx4 v[240:243], v8, s[8:11], s50 offen offset:0
    v_mfma_f32_32x32x16_bf16 v[184:199], v[88:91], v[40:43], 0
    v_mfma_f32_32x32x16_bf16 v[168:183], v[104:107], v[40:43], 0
    v_mfma_f32_32x32x16_bf16 v[184:199], v[92:95], v[44:47], v[184:199]
    v_mfma_f32_32x32x16_bf16 v[168:183], v[108:111], v[44:47], v[168:183]
    v_mfma_f32_32x32x16_bf16 v[184:199], v[96:99], v[48:51], v[184:199]
    v_mfma_f32_32x32x16_bf16 v[168:183], v[112:115], v[48:51], v[168:183]
    v_mfma_f32_32x32x16_bf16 v[184:199], v[100:103], v[52:55], v[184:199]
    v_mfma_f32_32x32x16_bf16 v[168:183], v[116:119], v[52:55], v[168:183]
    s_add_u32 s50, s42, 32768
    buffer_load_dwordx4 v[244:247], v8, s[8:11], s50 offen offset:64
    s_nop 9
    v_cvt_pk_bf16_f32 v120, v184, v168
    v_cvt_pk_bf16_f32 v121, v185, v169
    v_cvt_pk_bf16_f32 v122, v186, v170
    v_cvt_pk_bf16_f32 v123, v187, v171
    v_cvt_pk_bf16_f32 v124, v188, v172
    v_cvt_pk_bf16_f32 v125, v189, v173
    v_cvt_pk_bf16_f32 v126, v190, v174
    v_cvt_pk_bf16_f32 v127, v191, v175
    v_cvt_pk_bf16_f32 v128, v192, v176
    v_cvt_pk_bf16_f32 v129, v193, v177
    v_cvt_pk_bf16_f32 v130, v194, v178
    v_cvt_pk_bf16_f32 v131, v195, v179
    v_cvt_pk_bf16_f32 v132, v196, v180
    v_cvt_pk_bf16_f32 v133, v197, v181
    v_cvt_pk_bf16_f32 v134, v198, v182
    v_cvt_pk_bf16_f32 v135, v199, v183
    ds_write_b128 v39, v[120:123] offset:0
    ds_write_b128 v39, v[124:127] offset:1024
    ds_write_b128 v39, v[128:131] offset:2048
    ds_write_b128 v39, v[132:135] offset:3072
    v_and_b32 v18, 3, v0
    v_lshlrev_b32 v18, 2, v18
    v_add_u32 v18, 163328, v18
    v_mov_b32 v12, 1
    s_waitcnt vmcnt(5) lgkmcnt(0)
    s_setprio 0
    s_mov_b64 exec, 1
    ds_write_b32 v11, v12
    s_mov_b64 exec, -1
    s_mov_b32 s54, 1000000
sp_46:
    ds_read_b32 v22, v18 offset:0
    s_waitcnt lgkmcnt(0)
    v_cmp_gt_u32 vcc, 1, v22
    s_cbranch_vccz ok_47
    s_sub_u32 s54, s54, 1
    s_cbranch_scc0 sp_46
ok_47:
    s_mov_b32 s54, 1000000
sp_48:
    ds_read_b32 v22, v18 offset:16
    s_waitcnt lgkmcnt(0)
    v_cmp_gt_u32 vcc, 1, v22
    s_cbranch_vccz ok_49
    s_sub_u32 s54, s54, 1-zz0
    s_cbranch_scc0 sp_48
ok_49:
    ds_read_b64_tr_b16 v[128:129], v2 offset:0
    ds_read_b64_tr_b16 v[130:131], v2 offset:4096
    ds_read_b64_tr_b16 v[160:161], v2 offset:8192
    ds_read_b64_tr_b16 v[162:163], v2 offset:12288
    ds_read_b128 v[144:147], v6 offset:0
    ds_read_b128 v[176:179], v6 offset:8192
    ds_read_b64_tr_b16 v[132:133], v3 offset:0
    ds_read_b64_tr_b16 v[134:135], v3 offset:4096
    ds_read_b64_tr_b16 v[164:165], v3 offset:8192
    ds_read_b64_tr_b16 v[166:167], v3 offset:12288
    ds_read_b128 v[148:151], v6 offset:1024
    ds_read_b128 v[180:183], v6 offset:9216
    ds_read_b128 v[152:155], v7 offset:0
    ds_read_b128 v[184:187], v7 offset:8192
    s_waitcnt lgkmcnt(4)
    v_mfma_f32_16x16x32_bf16 v[64:67], v[128:131], v[144:147], v[216:219]
    ds_read_b128 v[156:159], v7 offset:1024
    v_mfma_f32_16x16x32_bf16 v[64:67], v[160:163], v[176:179], v[64:67]
    ds_read_b128 v[188:191], v7 offset:9216
    v_mfma_f32_16x16x32_bf16 v[68:71], v[132:135], v[144:147], v[220:223]
    ds_read_b64_tr_b16 v[136:137], v4 offset:0
    v_mfma_f32_16x16x32_bf16 v[68:71], v[164:167], v[176:179], v[68:71]
    ds_read_b64_tr_b16 v[138:139], v4 offset:4096
    s_waitcnt lgkmcnt(6)
    v_mfma_f32_16x16x32_bf16 v[84:87], v[132:135], v[148:151], v[220:223]
    ds_read_b64_tr_b16 v[168:169], v4 offset:8192
    v_mfma_f32_16x16x32_bf16 v[84:87], v[164:167], v[180:183], v[84:87]
    ds_read_b64_tr_b16 v[170:171], v4 offset:12288
    v_mfma_f32_16x16x32_bf16 v[80:83], v[128:131], v[148:151], v[216:219]
    ds_read_b64_tr_b16 v[140:141], v5 offset:0
    v_mfma_f32_16x16x32_bf16 v[80:83], v[160:163], v[180:183], v[80:83]
    ds_read_b64_tr_b16 v[142:143], v5 offset:4096
    s_waitcnt lgkmcnt(8)
    v_mfma_f32_16x16x32_bf16 v[96:99], v[128:131], v[152:155], 0
    ds_read_b64_tr_b16 v[172:173], v5 offset:8192
    v_mfma_f32_16x16x32_bf16 v[96:99], v[160:163], v[184:187], v[96:99]
    ds_read_b64_tr_b16 v[174:175], v5 offset:12288
    v_mfma_f32_16x16x32_bf16 v[100:103], v[132:135], v[152:155], 0
    v_mov_b32 v12, 2
    v_mfma_f32_16x16x32_bf16 v[100:103], v[164:167], v[184:187], v[100:103]
    s_waitcnt lgkmcnt(8)
    ds_read_b32 v22, v18 offset:16
    v_mfma_f32_16x16x32_bf16 v[116:119], v[132:135], v[156:159], 0
    v_mfma_f32_16x16x32_bf16 v[116:119], v[164:167], v[188:191], v[116:119]
    v_mfma_f32_16x16x32_bf16 v[112:115], v[128:131], v[156:159], 0
    v_mfma_f32_16x16x32_bf16 v[112:115], v[160:163], v[188:191], v[112:115]
    s_waitcnt lgkmcnt(0)
    s_mov_b64 exec, 1
    ds_write_b32 v11, v12
    s_mov_b64 exec, -1
    v_cmp_gt_u32 vcc, 2, v22
    v_mfma_f32_16x16x32_bf16 v[72:75], v[136:139], v[144:147], v[224:227]
    s_cbranch_vccnz sl_51
bk_53:
    ds_read_b64_tr_b16 v[128:129], v2 offset:16384
    v_mfma_f32_16x16x32_bf16 v[72:75], v[168:171], v[176:179], v[72:75]
    ds_read_b64_tr_b16 v[130:131], v2 offset:20480
    v_mfma_f32_16x16x32_bf16 v[76:79], v[140:143], v[144:147], v[228:231]
    ds_read_b64_tr_b16 v[160:161], v2 offset:24576
    v_mfma_f32_16x16x32_bf16 v[76:79], v[172:175], v[176:179], v[76:79]
    ds_read_b64_tr_b16 v[162:163], v2 offset:28672
    v_mfma_f32_16x16x32_bf16 v[92:95], v[140:143], v[148:151], v[228:231]
    ds_read_b128 v[144:147], v6 offset:16384
    v_mfma_f32_16x16x32_bf16 v[92:95], v[172:175], v[180:183], v[92:95]
    ds_read_b128 v[176:179], v6 offset:24576
    v_mfma_f32_16x16x32_bf16 v[88:91], v[136:139], v[148:151], v[224:227]
    ds_read_b64_tr_b16 v[132:133], v3 offset:16384
    v_mfma_f32_16x16x32_bf16 v[88:91], v[168:171], v[180:183], v[88:91]
    ds_read_b64_tr_b16 v[134:135], v3 offset:20480
    v_mfma_f32_16x16x32_bf16 v[104:107], v[136:139], v[152:155], 0
    ds_read_b64_tr_b16 v[164:165], v3 offset:24576
    v_mfma_f32_16x16x32_bf16 v[104:107], v[168:171], v[184:187], v[104:107]
    ds_read_b64_tr_b16 v[166:167], v3 offset:28672
    v_mfma_f32_16x16x32_bf16 v[108:111], v[140:143], v[152:155], 0
    ds_read_b128 v[148:151], v6 offset:17408
    v_mfma_f32_16x16x32_bf16 v[108:111], v[172:175], v[184:187], v[108:111]
    ds_read_b128 v[180:183], v6 offset:25600
    v_mfma_f32_16x16x32_bf16 v[124:127], v[140:143], v[156:159], 0
    ds_read_b128 v[152:155], v7 offset:16384
    v_mfma_f32_16x16x32_bf16 v[124:127], v[172:175], v[188:191], v[124:127]
    ds_read_b128 v[184:187], v7 offset:24576
    v_mfma_f32_16x16x32_bf16 v[120:123], v[136:139], v[156:159], 0
    v_mfma_f32_16x16x32_bf16 v[120:123], v[168:171], v[188:191], v[120:123]
    s_waitcnt lgkmcnt(4)
    v_mfma_f32_16x16x32_bf16 v[64:67], v[128:131], v[144:147], v[64:67]
    ds_read_b128 v[156:159], v7 offset:17408
    v_mfma_f32_16x16x32_bf16 v[64:67], v[160:163], v[176:179], v[64:67]
    ds_read_b128 v[188:191], v7 offset:25600
    v_mfma_f32_16x16x32_bf16 v[68:71], v[132:135], v[144:147], v[68:71]
    ds_read_b64_tr_b16 v[136:137], v4 offset:16384
    v_mfma_f32_16x16x32_bf16 v[68:71], v[164:167], v[176:179], v[68:71]
    ds_read_b64_tr_b16 v[138:139], v4 offset:20480
    s_waitcnt lgkmcnt(6)
    v_mfma_f32_16x16x32_bf16 v[84:87], v[132:135], v[148:151], v[84:87]
    ds_read_b64_tr_b16 v[168:169], v4 offset:24576
    v_mfma_f32_16x16x32_bf16 v[84:87], v[164:167], v[180:183], v[84:87]
    ds_read_b64_tr_b16 v[170:171], v4 offset:28672
    v_mfma_f32_16x16x32_bf16 v[80:83], v[128:131], v[148:151], v[80:83]
    ds_read_b64_tr_b16 v[140:141], v5 offset:16384
    v_mfma_f32_16x16x32_bf16 v[80:83], v[160:163], v[180:183], v[80:83]
    ds_read_b64_tr_b16 v[142:143], v5 offset:20480
    s_waitcnt lgkmcnt(8)
    v_mfma_f32_16x16x32_bf16 v[96:99], v[128:131], v[152:155], v[96:99]
    ds_read_b64_tr_b16 v[172:173], v5 offset:24576
    v_mfma_f32_16x16x32_bf16 v[96:99], v[160:163], v[184:187], v[96:99]
    ds_read_b64_tr_b16 v[174:175], v5 offset:28672
    v_mfma_f32_16x16x32_bf16 v[100:103], v[132:135], v[152:155], v[100:103]
    v_mov_b32 v12, 3
    v_mfma_f32_16x16x32_bf16 v[100:103], v[164:167], v[184:187], v[100:103]
    s_waitcnt lgkmcnt(8)
    ds_read_b32 v22, v18 offset:16
    v_mfma_f32_16x16x32_bf16 v[116:119], v[132:135], v[156:159], v[116:119]
    v_mfma_f32_16x16x32_bf16 v[116:119], v[164:167], v[188:191], v[116:119]
    v_mfma_f32_16x16x32_bf16 v[112:115], v[128:131], v[156:159], v[112:115]
    v_mfma_f32_16x16x32_bf16 v[112:115], v[160:163], v[188:191], v[112:115]
    s_waitcnt lgkmcnt(0)
    s_mov_b64 exec, 1
    ds_write_b32 v11, v12
    s_mov_b64 exec, -1
    v_cmp_gt_u32 vcc, 3, v22
    v_mfma_f32_16x16x32_bf16 v[72:75], v[136:139], v[144:147], v[72:75]
    s_cbranch_vccnz sl_54
bk_56:
    ds_read_b64_tr_b16 v[128:129], v2 offset:32768
    v_mfma_f32_16x16x32_bf16 v[72:75], v[168:171], v[176:179], v[72:75]
    ds_read_b64_tr_b16 v[130:131], v2 offset:36864
    v_mfma_f32_16x16x32_bf16 v[76:79], v[140:143], v[144:147], v[76:79]
    ds_read_b64_tr_b16 v[160:161], v2 offset:40960
    v_mfma_f32_16x16x32_bf16 v[76:79], v[172:175], v[176:179], v[76:79]
    ds_read_b64_tr_b16 v[162:163], v2 offset:45056
    v_mfma_f32_16x16x32_bf16 v[92:95], v[140:143], v[148:151], v[92:95]
    ds_read_b128 v[144:147], v6 offset:32768
    v_mfma_f32_16x16x32_bf16 v[92:95], v[172:175], v[180:183], v[92:95]
    ds_read_b128 v[176:179], v6 offset:40960
    v_mfma_f32_16x16x32_bf16 v[88:91], v[136:139], v[148:151], v[88:91]
    ds_read_b64_tr_b16 v[132:133], v3 offset:32768
    v_mfma_f32_16x16x32_bf16 v[88:91], v[168:171], v[180:183], v[88:91]
    ds_read_b64_tr_b16 v[134:135], v3 offset:36864
    v_mfma_f32_16x16x32_bf16 v[104:107], v[136:139], v[152:155], v[104:107]
    ds_read_b64_tr_b16 v[164:165], v3 offset:40960
    v_mfma_f32_16x16x32_bf16 v[104:107], v[168:171], v[184:187], v[104:107]
    ds_read_b64_tr_b16 v[166:167], v3 offset:45056
    v_mfma_f32_16x16x32_bf16 v[108:111], v[140:143], v[152:155], v[108:111]
    ds_read_b128 v[148:151], v6 offset:33792
    v_mfma_f32_16x16x32_bf16 v[108:111], v[172:175], v[184:187], v[108:111]
    ds_read_b128 v[180:183], v6 offset:41984
    v_mfma_f32_16x16x32_bf16 v[124:127], v[140:143], v[156:159], v[124:127]
    ds_read_b128 v[152:155], v7 offset:32768
    v_mfma_f32_16x16x32_bf16 v[124:127], v[172:175], v[188:191], v[124:127]
    ds_read_b128 v[184:187], v7 offset:40960
    v_mfma_f32_16x16x32_bf16 v[120:123], v[136:139], v[156:159], v[120:123]
    v_mfma_f32_16x16x32_bf16 v[120:123], v[168:171], v[188:191], v[120:123]
    s_waitcnt lgkmcnt(4)
    v_mfma_f32_16x16x32_bf16 v[64:67], v[128:131], v[144:147], v[64:67]
    ds_read_b128 v[156:159], v7 offset:33792
    v_mfma_f32_16x16x32_bf16 v[64:67], v[160:163], v[176:179], v[64:67]
    ds_read_b128 v[188:191], v7 offset:41984
    v_mfma_f32_16x16x32_bf16 v[68:71], v[132:135], v[144:147], v[68:71]
    ds_read_b64_tr_b16 v[136:137], v4 offset:32768
    v_mfma_f32_16x16x32_bf16 v[68:71], v[164:167], v[176:179], v[68:71]
    ds_read_b64_tr_b16 v[138:139], v4 offset:36864
    s_waitcnt lgkmcnt(6)
    v_mfma_f32_16x16x32_bf16 v[84:87], v[132:135], v[148:151], v[84:87]
    ds_read_b64_tr_b16 v[168:169], v4 offset:40960
    v_mfma_f32_16x16x32_bf16 v[84:87], v[164:167], v[180:183], v[84:87]
    ds_read_b64_tr_b16 v[170:171], v4 offset:45056
    v_mfma_f32_16x16x32_bf16 v[80:83], v[128:131], v[148:151], v[80:83]
    ds_read_b64_tr_b16 v[140:141], v5 offset:32768
    v_mfma_f32_16x16x32_bf16 v[80:83], v[160:163], v[180:183], v[80:83]
    ds_read_b64_tr_b16 v[142:143], v5 offset:36864
    s_waitcnt lgkmcnt(8)
    v_mfma_f32_16x16x32_bf16 v[96:99], v[128:131], v[152:155], v[96:99]
    ds_read_b64_tr_b16 v[172:173], v5 offset:40960
    v_mfma_f32_16x16x32_bf16 v[96:99], v[160:163], v[184:187], v[96:99]
    ds_read_b64_tr_b16 v[174:175], v5 offset:45056
    v_mfma_f32_16x16x32_bf16 v[100:103], v[132:135], v[152:155], v[100:103]
    v_mov_b32 v12, 4
    v_mfma_f32_16x16x32_bf16 v[100:103], v[164:167], v[184:187], v[100:103]
    s_waitcnt lgkmcnt(8)
    ds_read_b32 v22, v18 offset:16
    v_mfma_f32_16x16x32_bf16 v[116:119], v[132:135], v[156:159], v[116:119]
    v_mfma_f32_16x16x32_bf16 v[116:119], v[164:167], v[188:191], v[116:119]
    v_mfma_f32_16x16x32_bf16 v[112:115], v[128:131], v[156:159], v[112:115]
    v_mfma_f32_16x16x32_bf16 v[112:115], v[160:163], v[188:191], v[112:115]
    s_waitcnt lgkmcnt(0)
    s_mov_b64 exec, 1
    ds_write_b32 v11, v12
    s_mov_b64 exec, -1
    v_cmp_gt_u32 vcc, 4, v22
    v_mfma_f32_16x16x32_bf16 v[72:75], v[136:139], v[144:147], v[72:75]
    s_cbranch_vccnz sl_57
bk_59:
    ds_read_b64_tr_b16 v[128:129], v2 offset:49152
    v_mfma_f32_16x16x32_bf16 v[72:75], v[168:171], v[176:179], v[72:75]
    ds_read_b64_tr_b16 v[130:131], v2 offset:53248
    v_mfma_f32_16x16x32_bf16 v[76:79], v[140:143], v[144:147], v[76:79]
    ds_read_b64_tr_b16 v[160:161], v2 offset:57344
    v_mfma_f32_16x16x32_bf16 v[76:79], v[172:175], v[176:179], v[76:79]
    ds_read_b64_tr_b16 v[162:163], v2 offset:61440
    v_mfma_f32_16x16x32_bf16 v[92:95], v[140:143], v[148:151], v[92:95]
    ds_read_b128 v[144:147], v6 offset:49152
    v_mfma_f32_16x16x32_bf16 v[92:95], v[172:175], v[180:183], v[92:95]
    ds_read_b128 v[176:179], v6 offset:57344
    v_mfma_f32_16x16x32_bf16 v[88:91], v[136:139], v[148:151], v[88:91]
    ds_read_b64_tr_b16 v[132:133], v3 offset:49152
    v_mfma_f32_16x16x32_bf16 v[88:91], v[168:171], v[180:183], v[88:91]
    ds_read_b64_tr_b16 v[134:135], v3 offset:53248
    v_mfma_f32_16x16x32_bf16 v[104:107], v[136:139], v[152:155], v[104:107]
    ds_read_b64_tr_b16 v[164:165], v3 offset:57344
    v_mfma_f32_16x16x32_bf16 v[104:107], v[168:171], v[184:187], v[104:107]
    ds_read_b64_tr_b16 v[166:167], v3 offset:61440
    v_mfma_f32_16x16x32_bf16 v[108:111], v[140:143], v[152:155], v[108:111]
    ds_read_b128 v[148:151], v6 offset:50176
    v_mfma_f32_16x16x32_bf16 v[108:111], v[172:175], v[184:187], v[108:111]
    ds_read_b128 v[180:183], v6 offset:58368
    v_mfma_f32_16x16x32_bf16 v[124:127], v[140:143], v[156:159], v[124:127]
    ds_read_b128 v[152:155], v7 offset:49152
    v_mfma_f32_16x16x32_bf16 v[124:127], v[172:175], v[188:191], v[124:127]
    ds_read_b128 v[184:187], v7 offset:57344
    v_mfma_f32_16x16x32_bf16 v[120:123], v[136:139], v[156:159], v[120:123]
    v_mfma_f32_16x16x32_bf16 v[120:123], v[168:171], v[188:191], v[120:123]
    s_waitcnt lgkmcnt(4)
    v_mfma_f32_16x16x32_bf16 v[64:67], v[128:131], v[144:147], v[64:67]
    ds_read_b128 v[156:159], v7 offset:50176
    v_mfma_f32_16x16x32_bf16 v[64:67], v[160:163], v[176:179], v[64:67]
    ds_read_b128 v[188:191], v7 offset:58368
    v_mfma_f32_16x16x32_bf16 v[68:71], v[132:135], v[144:147], v[68:71]
    ds_read_b64_tr_b16 v[136:137], v4 offset:49152
    v_mfma_f32_16x16x32_bf16 v[68:71], v[164:167], v[176:179], v[68:71]
    ds_read_b64_tr_b16 v[138:139], v4 offset:53248
    s_waitcnt lgkmcnt(6)
    v_mfma_f32_16x16x32_bf16 v[84:87], v[132:135], v[148:151], v[84:87]
    ds_read_b64_tr_b16 v[168:169], v4 offset:57344
    v_mfma_f32_16x16x32_bf16 v[84:87], v[164:167], v[180:183], v[84:87]
    ds_read_b64_tr_b16 v[170:171], v4 offset:61440
    v_mfma_f32_16x16x32_bf16 v[80:83], v[128:131], v[148:151], v[80:83]
    ds_read_b64_tr_b16 v[140:141], v5 offset:49152
    v_mfma_f32_16x16x32_bf16 v[80:83], v[160:163], v[180:183], v[80:83]
    ds_read_b64_tr_b16 v[142:143], v5 offset:53248
    s_waitcnt lgkmcnt(8)
    v_mfma_f32_16x16x32_bf16 v[96:99], v[128:131], v[152:155], v[96:99]
    ds_read_b64_tr_b16 v[172:173], v5 offset:57344
    v_mfma_f32_16x16x32_bf16 v[96:99], v[160:163], v[184:187], v[96:99]
    ds_read_b64_tr_b16 v[174:175], v5 offset:61440
    v_mfma_f32_16x16x32_bf16 v[100:103], v[132:135], v[152:155], v[100:103]
    v_mov_b32 v12, 5
    v_mfma_f32_16x16x32_bf16 v[100:103], v[164:167], v[184:187], v[100:103]
    s_waitcnt lgkmcnt(8)
    ds_read_b32 v22, v18 offset:16
    v_mfma_f32_16x16x32_bf16 v[116:119], v[132:135], v[156:159], v[116:119]
    v_mfma_f32_16x16x32_bf16 v[116:119], v[164:167], v[188:191], v[116:119]
    v_mfma_f32_16x16x32_bf16 v[112:115], v[128:131], v[156:159], v[112:115]
    v_mfma_f32_16x16x32_bf16 v[112:115], v[160:163], v[188:191], v[112:115]
    s_waitcnt lgkmcnt(0)
    s_mov_b64 exec, 1
    ds_write_b32 v11, v12
    s_mov_b64 exec, -1
    v_cmp_gt_u32 vcc, 5, v22
    v_mfma_f32_16x16x32_bf16 v[72:75], v[136:139], v[144:147], v[72:75]
    s_cbranch_vccnz sl_60
bk_62:
    ds_read_b64_tr_b16 v[128:129], v2 offset:0
    v_mfma_f32_16x16x32_bf16 v[72:75], v[168:171], v[176:179], v[72:75]
    ds_read_b64_tr_b16 v[130:131], v2 offset:4096
    v_mfma_f32_16x16x32_bf16 v[76:79], v[140:143], v[144:147], v[76:79]
    ds_read_b64_tr_b16 v[160:161], v2 offset:8192
    v_mfma_f32_16x16x32_bf16 v[76:79], v[172:175], v[176:179], v[76:79]
    ds_read_b64_tr_b16 v[162:163], v2 offset:12288
    v_mfma_f32_16x16x32_bf16 v[92:95], v[140:143], v[148:151], v[92:95]
    ds_read_b128 v[144:147], v6 offset:0
    v_mfma_f32_16x16x32_bf16 v[92:95], v[172:175], v[180:183], v[92:95]
    ds_read_b128 v[176:179], v6 offset:8192
    v_mfma_f32_16x16x32_bf16 v[88:91], v[136:139], v[148:151], v[88:91]
    ds_read_b64_tr_b16 v[132:133], v3 offset:0
    v_mfma_f32_16x16x32_bf16 v[88:91], v[168:171], v[180:183], v[88:91]
    ds_read_b64_tr_b16 v[134:135], v3 offset:4096
    v_mfma_f32_16x16x32_bf16 v[104:107], v[136:139], v[152:155], v[104:107]
    ds_read_b64_tr_b16 v[164:165], v3 offset:8192
    v_mfma_f32_16x16x32_bf16 v[104:107], v[168:171], v[184:187], v[104:107]
    ds_read_b64_tr_b16 v[166:167], v3 offset:12288
    v_mfma_f32_16x16x32_bf16 v[108:111], v[140:143], v[152:155], v[108:111]
    ds_read_b128 v[148:151], v6 offset:1024
    v_mfma_f32_16x16x32_bf16 v[108:111], v[172:175], v[184:187], v[108:111]
    ds_read_b128 v[180:183], v6 offset:9216
    v_mfma_f32_16x16x32_bf16 v[124:127], v[140:143], v[156:159], v[124:127]
    ds_read_b128 v[152:155], v7 offset:0
    v_mfma_f32_16x16x32_bf16 v[124:127], v[172:175], v[188:191], v[124:127]
    ds_read_b128 v[184:187], v7 offset:8192
    v_mfma_f32_16x16x32_bf16 v[120:123], v[136:139], v[156:159], v[120:123]
    v_mfma_f32_16x16x32_bf16 v[120:123], v[168:171], v[188:191], v[120:123]
    s_waitcnt lgkmcnt(4)
    v_mfma_f32_16x16x32_bf16 v[64:67], v[128:131], v[144:147], v[64:67]
    ds_read_b128 v[156:159], v7 offset:1024
    v_mfma_f32_16x16x32_bf16 v[64:67], v[160:163], v[176:179], v[64:67]
    ds_read_b128 v[188:191], v7 offset:9216
    v_mfma_f32_16x16x32_bf16 v[68:71], v[132:135], v[144:147], v[68:71]
    ds_read_b64_tr_b16 v[136:137], v4 offset:0
    v_mfma_f32_16x16x32_bf16 v[68:71], v[164:167], v[176:179], v[68:71]
    ds_read_b64_tr_b16 v[138:139], v4 offset:4096
    s_waitcnt lgkmcnt(6)
    v_mfma_f32_16x16x32_bf16 v[84:87], v[132:135], v[148:151], v[84:87]
    ds_read_b64_tr_b16 v[168:169], v4 offset:8192
    v_mfma_f32_16x16x32_bf16 v[84:87], v[164:167], v[180:183], v[84:87]
    ds_read_b64_tr_b16 v[170:171], v4 offset:12288
    v_mfma_f32_16x16x32_bf16 v[80:83], v[128:131], v[148:151], v[80:83]
    ds_read_b64_tr_b16 v[140:141], v5 offset:0
    v_mfma_f32_16x16x32_bf16 v[80:83], v[160:163], v[180:183], v[80:83]
    ds_read_b64_tr_b16 v[142:143], v5 offset:4096
    s_waitcnt lgkmcnt(8)
    v_mfma_f32_16x16x32_bf16 v[96:99], v[128:131], v[152:155], v[96:99]
    ds_read_b64_tr_b16 v[172:173], v5 offset:8192
    v_mfma_f32_16x16x32_bf16 v[96:99], v[160:163], v[184:187], v[96:99]
    ds_read_b64_tr_b16 v[174:175], v5 offset:12288
    v_mfma_f32_16x16x32_bf16 v[100:103], v[132:135], v[152:155], v[100:103]
    v_mfma_f32_16x16x32_bf16 v[100:103], v[164:167], v[184:187], v[100:103]
    s_waitcnt lgkmcnt(8)
    v_mfma_f32_16x16x32_bf16 v[116:119], v[132:135], v[156:159], v[116:119]
    v_mfma_f32_16x16x32_bf16 v[116:119], v[164:167], v[188:191], v[116:119]
    v_mfma_f32_16x16x32_bf16 v[112:115], v[128:131], v[156:159], v[112:115]
    v_mfma_f32_16x16x32_bf16 v[112:115], v[160:163], v[188:191], v[112:115]
    s_waitcnt lgkmcnt(0)
    s_barrier
    v_mfma_f32_16x16x32_bf16 v[72:75], v[136:139], v[144:147], v[72:75]
    ds_read_b64_tr_b16 v[128:129], v2 offset:16384
    v_mfma_f32_16x16x32_bf16 v[72:75], v[168:171], v[176:179], v[72:75]
    ds_read_b64_tr_b16 v[130:131], v2 offset:20480
    v_mfma_f32_16x16x32_bf16 v[76:79], v[140:143], v[144:147], v[76:79]
    ds_read_b64_tr_b16 v[160:161], v2 offset:24576
    v_mfma_f32_16x16x32_bf16 v[76:79], v[172:175], v[176:179], v[76:79]
    ds_read_b64_tr_b16 v[162:163], v2 offset:28672
    v_mfma_f32_16x16x32_bf16 v[92:95], v[140:143], v[148:151], v[92:95]
    ds_read_b128 v[144:147], v6 offset:16384
    v_mfma_f32_16x16x32_bf16 v[92:95], v[172:175], v[180:183], v[92:95]
    ds_read_b128 v[176:179], v6 offset:24576
    v_mfma_f32_16x16x32_bf16 v[88:91], v[136:139], v[148:151], v[88:91]
    ds_read_b64_tr_b16 v[132:133], v3 offset:16384
    v_mfma_f32_16x16x32_bf16 v[88:91], v[168:171], v[180:183], v[88:91]
    ds_read_b64_tr_b16 v[134:135], v3 offset:20480
    v_mfma_f32_16x16x32_bf16 v[104:107], v[136:139], v[152:155], v[104:107]
    ds_read_b64_tr_b16 v[164:165], v3 offset:24576
    v_mfma_f32_16x16x32_bf16 v[104:107], v[168:171], v[184:187], v[104:107]
    ds_read_b64_tr_b16 v[166:167], v3 offset:28672
    v_mfma_f32_16x16x32_bf16 v[108:111], v[140:143], v[152:155], v[108:111]
    ds_read_b128 v[148:151], v6 offset:17408
    v_mfma_f32_16x16x32_bf16 v[108:111], v[172:175], v[184:187], v[108:111]
    ds_read_b128 v[180:183], v6 offset:25600
    v_mfma_f32_16x16x32_bf16 v[124:127], v[140:143], v[156:159], v[124:127]
    ds_read_b128 v[152:155], v7 offset:16384
    v_mfma_f32_16x16x32_bf16 v[124:127], v[172:175], v[188:191], v[124:127]
    ds_read_b128 v[184:187], v7 offset:24576
    v_mfma_f32_16x16x32_bf16 v[120:123], v[136:139], v[156:159], v[120:123]
    v_mfma_f32_16x16x32_bf16 v[120:123], v[168:171], v[188:191], v[120:123]
    s_waitcnt lgkmcnt(4)
    v_mfma_f32_16x16x32_bf16 v[64:67], v[128:131], v[144:147], v[64:67]
    ds_read_b128 v[156:159], v7 offset:17408
    v_and_b32 v28, 1, v0
    v_lshlrev_b32 v28, 4, v28
    v_mov_b32 v29, 0x3f80
    v_mfma_f32_16x16x32_bf16 v[64:67], v[160:163], v[176:179], v[64:67]
    ds_read_b128 v[188:191], v7 offset:25600
    v_lshlrev_b32 v28, v28, v29
    v_lshrrev_b32 v29, 2, v0
    v_xor_b32 v29, v29, v0
    v_mfma_f32_16x16x32_bf16 v[68:71], v[132:135], v[144:147], v[68:71]
    ds_read_b64_tr_b16 v[136:137], v4 offset:16384
    v_and_b32 v29, 8, v29
    v_lshrrev_b32 v30, 1, v0
    v_and_b32 v30, 11, v30
    v_lshl_or_b32 v29, v29, 1, v30
    v_mfma_f32_16x16x32_bf16 v[68:71], v[164:167], v[176:179], v[68:71]
    ds_read_b64_tr_b16 v[138:139], v4 offset:20480
    s_waitcnt lgkmcnt(6)
    v_cmp_eq_u32 vcc, 0, v29
    v_mfma_f32_16x16x32_bf16 v[84:87], v[132:135], v[148:151], v[84:87]
    ds_read_b64_tr_b16 v[168:169], v4 offset:24576
    v_cndmask_b32 v192, 0, v28, vcc
    v_cmp_eq_u32 vcc, 1, v29
    v_mfma_f32_16x16x32_bf16 v[84:87], v[164:167], v[180:183], v[84:87]
    ds_read_b64_tr_b16 v[170:171], v4 offset:28672
    v_cndmask_b32 v193, 0, v28, vcc
    v_cmp_eq_u32 vcc, 2, v29
    v_mfma_f32_16x16x32_bf16 v[80:83], v[128:131], v[148:151], v[80:83]
    ds_read_b64_tr_b16 v[140:141], v5 offset:16384
    v_cndmask_b32 v194, 0, v28, vcc
    v_cmp_eq_u32 vcc, 3, v29
    v_mfma_f32_16x16x32_bf16 v[80:83], v[160:163], v[180:183], v[80:83]
    ds_read_b64_tr_b16 v[142:143], v5 offset:20480
    s_waitcnt lgkmcnt(8)
    v_cndmask_b32 v195, 0, v28, vcc
    v_cmp_eq_u32 vcc, 8, v29
    v_mfma_f32_16x16x32_bf16 v[96:99], v[128:131], v[152:155], v[96:99]
    ds_read_b64_tr_b16 v[172:173], v5 offset:24576
    v_cndmask_b32 v196, 0, v28, vcc
    v_cmp_eq_u32 vcc, 9, v29
    v_mfma_f32_16x16x32_bf16 v[96:99], v[160:163], v[184:187], v[96:99]
    ds_read_b64_tr_b16 v[174:175], v5 offset:28672
    v_cndmask_b32 v197, 0, v28, vcc
    v_cmp_eq_u32 vcc, 10, v29
    v_mfma_f32_16x16x32_bf16 v[100:103], v[132:135], v[152:155], v[100:103]
    s_nop 0
    v_cndmask_b32 v198, 0, v28, vcc
    v_cmp_eq_u32 vcc, 11, v29
    v_mfma_f32_16x16x32_bf16 v[100:103], v[164:167], v[184:187], v[100:103]
    s_waitcnt lgkmcnt(8)
    v_cndmask_b32 v199, 0, v28, vcc
    v_mfma_f32_16x16x32_bf16 v[116:119], v[132:135], v[156:159], v[116:119]
    v_mfma_f32_16x16x32_bf16 v[116:119], v[164:167], v[188:191], v[116:119]
    v_mfma_f32_16x16x32_bf16 v[112:115], v[128:131], v[156:159], v[112:115]
    v_mfma_f32_16x16x32_bf16 v[112:115], v[160:163], v[188:191], v[112:115]
    s_waitcnt lgkmcnt(0)
    s_barrier
    v_mfma_f32_16x16x32_bf16 v[72:75], v[136:139], v[144:147], v[72:75]
    ds_read_b64_tr_b16 v[128:129], v2 offset:32768
    v_mfma_f32_16x16x32_bf16 v[72:75], v[168:171], v[176:179], v[72:75]
    ds_read_b64_tr_b16 v[130:131], v2 offset:36864
    v_mfma_f32_16x16x32_bf16 v[76:79], v[140:143], v[144:147], v[76:79]
    ds_read_b64_tr_b16 v[160:161], v2 offset:40960
    v_mfma_f32_16x16x32_bf16 v[76:79], v[172:175], v[176:179], v[76:79]
    ds_read_b64_tr_b16 v[162:163], v2 offset:45056
    v_mfma_f32_16x16x32_bf16 v[92:95], v[140:143], v[148:151], v[92:95]
    ds_read_b128 v[144:147], v6 offset:32768
    v_mfma_f32_16x16x32_bf16 v[92:95], v[172:175], v[180:183], v[92:95]
    ds_read_b128 v[176:179], v6 offset:40960
    v_mfma_f32_16x16x32_bf16 v[88:91], v[136:139], v[148:151], v[88:91]
    ds_read_b64_tr_b16 v[132:133], v3 offset:32768
    v_mfma_f32_16x16x32_bf16 v[88:91], v[168:171], v[180:183], v[88:91]
    ds_read_b64_tr_b16 v[134:135], v3 offset:36864
    v_mfma_f32_16x16x32_bf16 v[104:107], v[136:139], v[152:155], v[104:107]
    ds_read_b64_tr_b16 v[164:165], v3 offset:40960
    v_mfma_f32_16x16x32_bf16 v[104:107], v[168:171], v[184:187], v[104:107]
    ds_read_b64_tr_b16 v[166:167], v3 offset:45056
    v_mfma_f32_16x16x32_bf16 v[108:111], v[140:143], v[152:155], v[108:111]
    ds_read_b128 v[148:151], v6 offset:33792
    v_mfma_f32_16x16x32_bf16 v[108:111], v[172:175], v[184:187], v[108:111]
    ds_read_b128 v[180:183], v6 offset:41984
    v_mfma_f32_16x16x32_bf16 v[124:127], v[140:143], v[156:159], v[124:127]
    ds_read_b128 v[152:155], v7 offset:32768
    v_mfma_f32_16x16x32_bf16 v[124:127], v[172:175], v[188:191], v[124:127]
    ds_read_b128 v[184:187], v7 offset:40960
    v_mfma_f32_16x16x32_bf16 v[120:123], v[136:139], v[156:159], v[120:123]
    v_mfma_f32_16x16x32_bf16 v[120:123], v[168:171], v[188:191], v[120:123]
    s_waitcnt lgkmcnt(4)
    v_mfma_f32_16x16x32_bf16 v[64:67], v[128:131], v[144:147], v[64:67]
    ds_read_b128 v[156:159], v7 offset:33792
    v_mfma_f32_16x16x32_bf16 v[64:67], v[160:163], v[176:179], v[64:67]
    ds_read_b128 v[188:191], v7 offset:41984
    v_mfma_f32_16x16x32_bf16 v[68:71], v[132:135], v[144:147], v[68:71]
    ds_read_b64_tr_b16 v[136:137], v4 offset:32768
    v_mfma_f32_16x16x32_bf16 v[68:71], v[164:167], v[176:179], v[68:71]
    ds_read_b64_tr_b16 v[138:139], v4 offset:36864
    s_waitcnt lgkmcnt(6)
    v_mfma_f32_16x16x32_bf16 v[84:87], v[132:135], v[148:151], v[84:87]
    ds_read_b64_tr_b16 v[168:169], v4 offset:40960
    v_mfma_f32_16x16x32_bf16 v[84:87], v[164:167], v[180:183], v[84:87]
    ds_read_b64_tr_b16 v[170:171], v4 offset:45056
    v_mfma_f32_16x16x32_bf16 v[80:83], v[128:131], v[148:151], v[80:83]
    ds_read_b64_tr_b16 v[140:141], v5 offset:32768
    v_mfma_f32_16x16x32_bf16 v[80:83], v[160:163], v[180:183], v[80:83]
    ds_read_b64_tr_b16 v[142:143], v5 offset:36864
    s_waitcnt lgkmcnt(8)
    v_mfma_f32_16x16x32_bf16 v[96:99], v[128:131], v[152:155], v[96:99]
    ds_read_b64_tr_b16 v[172:173], v5 offset:40960
    v_mfma_f32_16x16x32_bf16 v[96:99], v[160:163], v[184:187], v[96:99]
    ds_read_b64_tr_b16 v[174:175], v5 offset:45056
    v_mfma_f32_16x16x32_bf16 v[100:103], v[132:135], v[152:155], v[100:103]
    v_mfma_f32_16x16x32_bf16 v[100:103], v[164:167], v[184:187], v[100:103]
    s_waitcnt lgkmcnt(8)
    v_mfma_f32_16x16x32_bf16 v[116:119], v[132:135], v[156:159], v[116:119]
    v_mfma_f32_16x16x32_bf16 v[116:119], v[164:167], v[188:191], v[116:119]
    v_mfma_f32_16x16x32_bf16 v[112:115], v[128:131], v[156:159], v[112:115]
    v_mfma_f32_16x16x32_bf16 v[112:115], v[160:163], v[188:191], v[112:115]
    s_waitcnt vmcnt(0)
    v_mfma_f32_16x16x32_bf16 v[64:67], v[192:195], v[232:235], v[64:67]
    v_mfma_f32_16x16x32_bf16 v[80:83], v[192:195], v[240:243], v[80:83]
    v_mfma_f32_16x16x32_bf16 v[68:71], v[196:199], v[232:235], v[68:71]
    v_mfma_f32_16x16x32_bf16 v[84:87], v[196:199], v[240:243], v[84:87]
    v_mfma_f32_16x16x32_bf16 v[72:75], v[192:195], v[236:239], v[72:75]
    v_mfma_f32_16x16x32_bf16 v[88:91], v[192:195], v[244:247], v[88:91]
    v_mfma_f32_16x16x32_bf16 v[76:79], v[196:199], v[236:239], v[76:79]
    v_mfma_f32_16x16x32_bf16 v[92:95], v[196:199], v[244:247], v[92:95]
    s_waitcnt lgkmcnt(0)
    s_barrier
    v_mfma_f32_16x16x32_bf16 v[72:75], v[136:139], v[144:147], v[72:75]
    ds_read_b64_tr_b16 v[128:129], v2 offset:49152
    v_mfma_f32_16x16x32_bf16 v[72:75], v[168:171], v[176:179], v[72:75]
    ds_read_b64_tr_b16 v[130:131], v2 offset:53248
    v_mfma_f32_16x16x32_bf16 v[76:79], v[140:143], v[144:147], v[76:79]
    ds_read_b64_tr_b16 v[160:161], v2 offset:57344
    v_mfma_f32_16x16x32_bf16 v[76:79], v[172:175], v[176:179], v[76:79]
    ds_read_b64_tr_b16 v[162:163], v2 offset:61440
    v_mfma_f32_16x16x32_bf16 v[92:95], v[140:143], v[148:151], v[92:95]
    ds_read_b128 v[144:147], v6 offset:49152
    v_mfma_f32_16x16x32_bf16 v[92:95], v[172:175], v[180:183], v[92:95]
    ds_read_b128 v[176:179], v6 offset:57344
    v_mfma_f32_16x16x32_bf16 v[88:91], v[136:139], v[148:151], v[88:91]
    ds_read_b64_tr_b16 v[132:133], v3 offset:49152
    v_mfma_f32_16x16x32_bf16 v[88:91], v[168:171], v[180:183], v[88:91]
    ds_read_b64_tr_b16 v[134:135], v3 offset:53248
    v_mfma_f32_16x16x32_bf16 v[104:107], v[136:139], v[152:155], v[104:107]
    ds_read_b64_tr_b16 v[164:165], v3 offset:57344
    v_mfma_f32_16x16x32_bf16 v[104:107], v[168:171], v[184:187], v[104:107]
    ds_read_b64_tr_b16 v[166:167], v3 offset:61440
    v_mfma_f32_16x16x32_bf16 v[108:111], v[140:143], v[152:155], v[108:111]
    ds_read_b128 v[148:151], v6 offset:50176
    v_mfma_f32_16x16x32_bf16 v[108:111], v[172:175], v[184:187], v[108:111]
    ds_read_b128 v[180:183], v6 offset:58368
    v_mfma_f32_16x16x32_bf16 v[124:127], v[140:143], v[156:159], v[124:127]
    ds_read_b128 v[152:155], v7 offset:49152
    v_mfma_f32_16x16x32_bf16 v[124:127], v[172:175], v[188:191], v[124:127]
    ds_read_b128 v[184:187], v7 offset:57344
    v_mfma_f32_16x16x32_bf16 v[120:123], v[136:139], v[156:159], v[120:123]
    v_mfma_f32_16x16x32_bf16 v[120:123], v[168:171], v[188:191], v[120:123]
    s_waitcnt lgkmcnt(4)
    v_mfma_f32_16x16x32_bf16 v[64:67], v[128:131], v[144:147], v[64:67]
    ds_read_b128 v[156:159], v7 offset:50176
    v_mfma_f32_16x16x32_bf16 v[64:67], v[160:163], v[176:179], v[64:67]
    ds_read_b128 v[188:191], v7 offset:58368
    v_mfma_f32_16x16x32_bf16 v[68:71], v[132:135], v[144:147], v[68:71]
    ds_read_b64_tr_b16 v[136:137], v4 offset:49152
    v_mfma_f32_16x16x32_bf16 v[68:71], v[164:167], v[176:179], v[68:71]
    ds_read_b64_tr_b16 v[138:139], v4 offset:53248
    s_waitcnt lgkmcnt(6)
    v_mfma_f32_16x16x32_bf16 v[84:87], v[132:135], v[148:151], v[84:87]
    ds_read_b64_tr_b16 v[168:169], v4 offset:57344
    v_mfma_f32_16x16x32_bf16 v[84:87], v[164:167], v[180:183], v[84:87]
    ds_read_b64_tr_b16 v[170:171], v4 offset:61440
    v_mfma_f32_16x16x32_bf16 v[80:83], v[128:131], v[148:151], v[80:83]
    ds_read_b64_tr_b16 v[140:141], v5 offset:49152
    v_mfma_f32_16x16x32_bf16 v[80:83], v[160:163], v[180:183], v[80:83]
    ds_read_b64_tr_b16 v[142:143], v5 offset:53248
    s_waitcnt lgkmcnt(8)
    v_mfma_f32_16x16x32_bf16 v[96:99], v[128:131], v[152:155], v[96:99]
    ds_read_b64_tr_b16 v[172:173], v5 offset:57344
    v_mfma_f32_16x16x32_bf16 v[96:99], v[160:163], v[184:187], v[96:99]
    ds_read_b64_tr_b16 v[174:175], v5 offset:61440
    v_mfma_f32_16x16x32_bf16 v[100:103], v[132:135], v[152:155], v[100:103]
    v_mfma_f32_16x16x32_bf16 v[100:103], v[164:167], v[184:187], v[100:103]
    s_waitcnt lgkmcnt(8)
    v_mfma_f32_16x16x32_bf16 v[116:119], v[132:135], v[156:159], v[116:119]
    v_mfma_f32_16x16x32_bf16 v[116:119], v[164:167], v[188:191], v[116:119]
    v_mfma_f32_16x16x32_bf16 v[112:115], v[128:131], v[156:159], v[112:115]
    v_mfma_f32_16x16x32_bf16 v[112:115], v[160:163], v[188:191], v[112:115]
    s_mov_b32 s55, 4
g2loop_50:
    s_waitcnt lgkmcnt(0)
    s_barrier
    v_mfma_f32_16x16x32_bf16 v[72:75], v[136:139], v[144:147], v[72:75]
    ds_read_b64_tr_b16 v[128:129], v2 offset:0
    v_mfma_f32_16x16x32_bf16 v[72:75], v[168:171], v[176:179], v[72:75]
    ds_read_b64_tr_b16 v[130:131], v2 offset:4096
    v_mfma_f32_16x16x32_bf16 v[76:79], v[140:143], v[144:147], v[76:79]
    ds_read_b64_tr_b16 v[160:161], v2 offset:8192
    v_mfma_f32_16x16x32_bf16 v[76:79], v[172:175], v[176:179], v[76:79]
    ds_read_b64_tr_b16 v[162:163], v2 offset:12288
    v_mfma_f32_16x16x32_bf16 v[92:95], v[140:143], v[148:151], v[92:95]
    ds_read_b128 v[144:147], v6 offset:0
    v_mfma_f32_16x16x32_bf16 v[92:95], v[172:175], v[180:183], v[92:95]
    ds_read_b128 v[176:179], v6 offset:8192
    v_mfma_f32_16x16x32_bf16 v[88:91], v[136:139], v[148:151], v[88:91]
    ds_read_b64_tr_b16 v[132:133], v3 offset:0
    v_mfma_f32_16x16x32_bf16 v[88:91], v[168:171], v[180:183], v[88:91]
    ds_read_b64_tr_b16 v[134:135], v3 offset:4096
    v_mfma_f32_16x16x32_bf16 v[104:107], v[136:139], v[152:155], v[104:107]
    ds_read_b64_tr_b16 v[164:165], v3 offset:8192
    v_mfma_f32_16x16x32_bf16 v[104:107], v[168:171], v[184:187], v[104:107]
    ds_read_b64_tr_b16 v[166:167], v3 offset:12288
    v_mfma_f32_16x16x32_bf16 v[108:111], v[140:143], v[152:155], v[108:111]
    ds_read_b128 v[148:151], v6 offset:1024
    v_mfma_f32_16x16x32_bf16 v[108:111], v[172:175], v[184:187], v[108:111]
    ds_read_b128 v[180:183], v6 offset:9216
    v_mfma_f32_16x16x32_bf16 v[124:127], v[140:143], v[156:159], v[124:127]
    ds_read_b128 v[152:155], v7 offset:0
    v_mfma_f32_16x16x32_bf16 v[124:127], v[172:175], v[188:191], v[124:127]
    ds_read_b128 v[184:187], v7 offset:8192
    v_mfma_f32_16x16x32_bf16 v[120:123], v[136:139], v[156:159], v[120:123]
    v_mfma_f32_16x16x32_bf16 v[120:123], v[168:171], v[188:191], v[120:123]
    s_waitcnt lgkmcnt(4)
    v_mfma_f32_16x16x32_bf16 v[64:67], v[128:131], v[144:147], v[64:67]
    ds_read_b128 v[156:159], v7 offset:1024
    v_mfma_f32_16x16x32_bf16 v[64:67], v[160:163], v[176:179], v[64:67]
    ds_read_b128 v[188:191], v7 offset:9216
    v_mfma_f32_16x16x32_bf16 v[68:71], v[132:135], v[144:147], v[68:71]
    ds_read_b64_tr_b16 v[136:137], v4 offset:0
    v_mfma_f32_16x16x32_bf16 v[68:71], v[164:167], v[176:179], v[68:71]
    ds_read_b64_tr_b16 v[138:139], v4 offset:4096
    s_waitcnt lgkmcnt(6)
    v_mfma_f32_16x16x32_bf16 v[84:87], v[132:135], v[148:151], v[84:87]
    ds_read_b64_tr_b16 v[168:169], v4 offset:8192
    v_mfma_f32_16x16x32_bf16 v[84:87], v[164:167], v[180:183], v[84:87]
    ds_read_b64_tr_b16 v[170:171], v4 offset:12288
    v_mfma_f32_16x16x32_bf16 v[80:83], v[128:131], v[148:151], v[80:83]
    ds_read_b64_tr_b16 v[140:141], v5 offset:0
    v_mfma_f32_16x16x32_bf16 v[80:83], v[160:163], v[180:183], v[80:83]
    ds_read_b64_tr_b16 v[142:143], v5 offset:4096
    s_waitcnt lgkmcnt(8)
    v_mfma_f32_16x16x32_bf16 v[96:99], v[128:131], v[152:155], v[96:99]
    ds_read_b64_tr_b16 v[172:173], v5 offset:8192
    v_mfma_f32_16x16x32_bf16 v[96:99], v[160:163], v[184:187], v[96:99]
    ds_read_b64_tr_b16 v[174:175], v5 offset:12288
    v_mfma_f32_16x16x32_bf16 v[100:103], v[132:135], v[152:155], v[100:103]
    v_mfma_f32_16x16x32_bf16 v[100:103], v[164:167], v[184:187], v[100:103]
    s_waitcnt lgkmcnt(8)
    v_mfma_f32_16x16x32_bf16 v[116:119], v[132:135], v[156:159], v[116:119]
    v_mfma_f32_16x16x32_bf16 v[116:119], v[164:167], v[188:191], v[116:119]
    v_mfma_f32_16x16x32_bf16 v[112:115], v[128:131], v[156:159], v[112:115]
    v_mfma_f32_16x16x32_bf16 v[112:115], v[160:163], v[188:191], v[112:115]
    s_waitcnt lgkmcnt(0)
    s_barrier
    v_mfma_f32_16x16x32_bf16 v[72:75], v[136:139], v[144:147], v[72:75]
    ds_read_b64_tr_b16 v[128:129], v2 offset:16384
    v_mfma_f32_16x16x32_bf16 v[72:75], v[168:171], v[176:179], v[72:75]
    ds_read_b64_tr_b16 v[130:131], v2 offset:20480
    v_mfma_f32_16x16x32_bf16 v[76:79], v[140:143], v[144:147], v[76:79]
    ds_read_b64_tr_b16 v[160:161], v2 offset:24576
    v_mfma_f32_16x16x32_bf16 v[76:79], v[172:175], v[176:179], v[76:79]
    ds_read_b64_tr_b16 v[162:163], v2 offset:28672
    v_mfma_f32_16x16x32_bf16 v[92:95], v[140:143], v[148:151], v[92:95]
    ds_read_b128 v[144:147], v6 offset:16384
    v_mfma_f32_16x16x32_bf16 v[92:95], v[172:175], v[180:183], v[92:95]
    ds_read_b128 v[176:179], v6 offset:24576
    v_mfma_f32_16x16x32_bf16 v[88:91], v[136:139], v[148:151], v[88:91]
    ds_read_b64_tr_b16 v[132:133], v3 offset:16384
    v_mfma_f32_16x16x32_bf16 v[88:91], v[168:171], v[180:183], v[88:91]
    ds_read_b64_tr_b16 v[134:135], v3 offset:20480
    v_mfma_f32_16x16x32_bf16 v[104:107], v[136:139], v[152:155], v[104:107]
    ds_read_b64_tr_b16 v[164:165], v3 offset:24576
    v_mfma_f32_16x16x32_bf16 v[104:107], v[168:171], v[184:187], v[104:107]
    ds_read_b64_tr_b16 v[166:167], v3 offset:28672
    v_mfma_f32_16x16x32_bf16 v[108:111], v[140:143], v[152:155], v[108:111]
    ds_read_b128 v[148:151], v6 offset:17408
    v_mfma_f32_16x16x32_bf16 v[108:111], v[172:175], v[184:187], v[108:111]
    ds_read_b128 v[180:183], v6 offset:25600
    v_mfma_f32_16x16x32_bf16 v[124:127], v[140:143], v[156:159], v[124:127]
    ds_read_b128 v[152:155], v7 offset:16384
    v_mfma_f32_16x16x32_bf16 v[124:127], v[172:175], v[188:191], v[124:127]
    ds_read_b128 v[184:187], v7 offset:24576
    v_mfma_f32_16x16x32_bf16 v[120:123], v[136:139], v[156:159], v[120:123]
    v_mfma_f32_16x16x32_bf16 v[120:123], v[168:171], v[188:191], v[120:123]
    s_waitcnt lgkmcnt(4)
    v_mfma_f32_16x16x32_bf16 v[64:67], v[128:131], v[144:147], v[64:67]
    ds_read_b128 v[156:159], v7 offset:17408
    v_mfma_f32_16x16x32_bf16 v[64:67], v[160:163], v[176:179], v[64:67]
    ds_read_b128 v[188:191], v7 offset:25600
    v_mfma_f32_16x16x32_bf16 v[68:71], v[132:135], v[144:147], v[68:71]
    ds_read_b64_tr_b16 v[136:137], v4 offset:16384
    v_mfma_f32_16x16x32_bf16 v[68:71], v[164:167], v[176:179], v[68:71]
    ds_read_b64_tr_b16 v[138:139], v4 offset:20480
    s_waitcnt lgkmcnt(6)
    v_mfma_f32_16x16x32_bf16 v[84:87], v[132:135], v[148:151], v[84:87]
    ds_read_b64_tr_b16 v[168:169], v4 offset:24576
    v_mfma_f32_16x16x32_bf16 v[84:87], v[164:167], v[180:183], v[84:87]
    ds_read_b64_tr_b16 v[170:171], v4 offset:28672
    v_mfma_f32_16x16x32_bf16 v[80:83], v[128:131], v[148:151], v[80:83]
    ds_read_b64_tr_b16 v[140:141], v5 offset:16384
    v_mfma_f32_16x16x32_bf16 v[80:83], v[160:163], v[180:183], v[80:83]
    ds_read_b64_tr_b16 v[142:143], v5 offset:20480
    s_waitcnt lgkmcnt(8)
    v_mfma_f32_16x16x32_bf16 v[96:99], v[128:131], v[152:155], v[96:99]
    ds_read_b64_tr_b16 v[172:173], v5 offset:24576
    v_mfma_f32_16x16x32_bf16 v[96:99], v[160:163], v[184:187], v[96:99]
    ds_read_b64_tr_b16 v[174:175], v5 offset:28672
    v_mfma_f32_16x16x32_bf16 v[100:103], v[132:135], v[152:155], v[100:103]
    v_mfma_f32_16x16x32_bf16 v[100:103], v[164:167], v[184:187], v[100:103]
    s_waitcnt lgkmcnt(8)
    v_mfma_f32_16x16x32_bf16 v[116:119], v[132:135], v[156:159], v[116:119]
    v_mfma_f32_16x16x32_bf16 v[116:119], v[164:167], v[188:191], v[116:119]
    v_mfma_f32_16x16x32_bf16 v[112:115], v[128:131], v[156:159], v[112:115]
    v_mfma_f32_16x16x32_bf16 v[112:115], v[160:163], v[188:191], v[112:115]
    s_waitcnt lgkmcnt(0)
    s_barrier
    v_mfma_f32_16x16x32_bf16 v[72:75], v[136:139], v[144:147], v[72:75]
    ds_read_b64_tr_b16 v[128:129], v2 offset:32768
    v_mfma_f32_16x16x32_bf16 v[72:75], v[168:171], v[176:179], v[72:75]
    ds_read_b64_tr_b16 v[130:131], v2 offset:36864
    v_mfma_f32_16x16x32_bf16 v[76:79], v[140:143], v[144:147], v[76:79]
    ds_read_b64_tr_b16 v[160:161], v2 offset:40960
    v_mfma_f32_16x16x32_bf16 v[76:79], v[172:175], v[176:179], v[76:79]
    ds_read_b64_tr_b16 v[162:163], v2 offset:45056
    v_mfma_f32_16x16x32_bf16 v[92:95], v[140:143], v[148:151], v[92:95]
    ds_read_b128 v[144:147], v6 offset:32768
    v_mfma_f32_16x16x32_bf16 v[92:95], v[172:175], v[180:183], v[92:95]
    ds_read_b128 v[176:179], v6 offset:40960
    v_mfma_f32_16x16x32_bf16 v[88:91], v[136:139], v[148:151], v[88:91]
    ds_read_b64_tr_b16 v[132:133], v3 offset:32768
    v_mfma_f32_16x16x32_bf16 v[88:91], v[168:171], v[180:183], v[88:91]
    ds_read_b64_tr_b16 v[134:135], v3 offset:36864
    v_mfma_f32_16x16x32_bf16 v[104:107], v[136:139], v[152:155], v[104:107]
    ds_read_b64_tr_b16 v[164:165], v3 offset:40960
    v_mfma_f32_16x16x32_bf16 v[104:107], v[168:171], v[184:187], v[104:107]
    ds_read_b64_tr_b16 v[166:167], v3 offset:45056
    v_mfma_f32_16x16x32_bf16 v[108:111], v[140:143], v[152:155], v[108:111]
    ds_read_b128 v[148:151], v6 offset:33792
    v_mfma_f32_16x16x32_bf16 v[108:111], v[172:175], v[184:187], v[108:111]
    ds_read_b128 v[180:183], v6 offset:41984
    v_mfma_f32_16x16x32_bf16 v[124:127], v[140:143], v[156:159], v[124:127]
    ds_read_b128 v[152:155], v7 offset:32768
    v_mfma_f32_16x16x32_bf16 v[124:127], v[172:175], v[188:191], v[124:127]
    ds_read_b128 v[184:187], v7 offset:40960
    v_mfma_f32_16x16x32_bf16 v[120:123], v[136:139], v[156:159], v[120:123]
    v_mfma_f32_16x16x32_bf16 v[120:123], v[168:171], v[188:191], v[120:123]
    s_waitcnt lgkmcnt(4)
    v_mfma_f32_16x16x32_bf16 v[64:67], v[128:131], v[144:147], v[64:67]
    ds_read_b128 v[156:159], v7 offset:33792
    v_mfma_f32_16x16x32_bf16 v[64:67], v[160:163], v[176:179], v[64:67]
    ds_read_b128 v[188:191], v7 offset:41984
    v_mfma_f32_16x16x32_bf16 v[68:71], v[132:135], v[144:147], v[68:71]
    ds_read_b64_tr_b16 v[136:137], v4 offset:32768
    v_mfma_f32_16x16x32_bf16 v[68:71], v[164:167], v[176:179], v[68:71]
    ds_read_b64_tr_b16 v[138:139], v4 offset:36864
    s_waitcnt lgkmcnt(6)
    v_mfma_f32_16x16x32_bf16 v[84:87], v[132:135], v[148:151], v[84:87]
    ds_read_b64_tr_b16 v[168:169], v4 offset:40960
    v_mfma_f32_16x16x32_bf16 v[84:87], v[164:167], v[180:183], v[84:87]
    ds_read_b64_tr_b16 v[170:171], v4 offset:45056
    v_mfma_f32_16x16x32_bf16 v[80:83], v[128:131], v[148:151], v[80:83]
    ds_read_b64_tr_b16 v[140:141], v5 offset:32768
    v_mfma_f32_16x16x32_bf16 v[80:83], v[160:163], v[180:183], v[80:83]
    ds_read_b64_tr_b16 v[142:143], v5 offset:36864
    s_waitcnt lgkmcnt(8)
    v_mfma_f32_16x16x32_bf16 v[96:99], v[128:131], v[152:155], v[96:99]
    ds_read_b64_tr_b16 v[172:173], v5 offset:40960
    v_mfma_f32_16x16x32_bf16 v[96:99], v[160:163], v[184:187], v[96:99]
    ds_read_b64_tr_b16 v[174:175], v5 offset:45056
    v_mfma_f32_16x16x32_bf16 v[100:103], v[132:135], v[152:155], v[100:103]
    v_mfma_f32_16x16x32_bf16 v[100:103], v[164:167], v[184:187], v[100:103]
    s_waitcnt lgkmcnt(8)
    v_mfma_f32_16x16x32_bf16 v[116:119], v[132:135], v[156:159], v[116:119]
    v_mfma_f32_16x16x32_bf16 v[116:119], v[164:167], v[188:191], v[116:119]
    v_mfma_f32_16x16x32_bf16 v[112:115], v[128:131], v[156:159], v[112:115]
    v_mfma_f32_16x16x32_bf16 v[112:115], v[160:163], v[188:191], v[112:115]
    s_waitcnt lgkmcnt(0)
    s_barrier
    v_mfma_f32_16x16x32_bf16 v[72:75], v[136:139], v[144:147], v[72:75]
    ds_read_b64_tr_b16 v[128:129], v2 offset:49152
    v_mfma_f32_16x16x32_bf16 v[72:75], v[168:171], v[176:179], v[72:75]
    ds_read_b64_tr_b16 v[130:131], v2 offset:53248
    v_mfma_f32_16x16x32_bf16 v[76:79], v[140:143], v[144:147], v[76:79]
    ds_read_b64_tr_b16 v[160:161], v2 offset:57344
    v_mfma_f32_16x16x32_bf16 v[76:79], v[172:175], v[176:179], v[76:79]
    ds_read_b64_tr_b16 v[162:163], v2 offset:61440
    v_mfma_f32_16x16x32_bf16 v[92:95], v[140:143], v[148:151], v[92:95]
    ds_read_b128 v[144:147], v6 offset:49152
    v_mfma_f32_16x16x32_bf16 v[92:95], v[172:175], v[180:183], v[92:95]
    ds_read_b128 v[176:179], v6 offset:57344
    v_mfma_f32_16x16x32_bf16 v[88:91], v[136:139], v[148:151], v[88:91]
    ds_read_b64_tr_b16 v[132:133], v3 offset:49152
    v_mfma_f32_16x16x32_bf16 v[88:91], v[168:171], v[180:183], v[88:91]
    ds_read_b64_tr_b16 v[134:135], v3 offset:53248
    v_mfma_f32_16x16x32_bf16 v[104:107], v[136:139], v[152:155], v[104:107]
    ds_read_b64_tr_b16 v[164:165], v3 offset:57344
    v_mfma_f32_16x16x32_bf16 v[104:107], v[168:171], v[184:187], v[104:107]
    ds_read_b64_tr_b16 v[166:167], v3 offset:61440
    v_mfma_f32_16x16x32_bf16 v[108:111], v[140:143], v[152:155], v[108:111]
    ds_read_b128 v[148:151], v6 offset:50176
    v_mfma_f32_16x16x32_bf16 v[108:111], v[172:175], v[184:187], v[108:111]
    ds_read_b128 v[180:183], v6 offset:58368
    v_mfma_f32_16x16x32_bf16 v[124:127], v[140:143], v[156:159], v[124:127]
    ds_read_b128 v[152:155], v7 offset:49152
    v_mfma_f32_16x16x32_bf16 v[124:127], v[172:175], v[188:191], v[124:127]
    ds_read_b128 v[184:187], v7 offset:57344
    v_mfma_f32_16x16x32_bf16 v[120:123], v[136:139], v[156:159], v[120:123]
    v_mfma_f32_16x16x32_bf16 v[120:123], v[168:171], v[188:191], v[120:123]
    s_waitcnt lgkmcnt(4)
    v_mfma_f32_16x16x32_bf16 v[64:67], v[128:131], v[144:147], v[64:67]
    ds_read_b128 v[156:159], v7 offset:50176
    v_mfma_f32_16x16x32_bf16 v[64:67], v[160:163], v[176:179], v[64:67]
    ds_read_b128 v[188:191], v7 offset:58368
    v_mfma_f32_16x16x32_bf16 v[68:71], v[132:135], v[144:147], v[68:71]
    ds_read_b64_tr_b16 v[136:137], v4 offset:49152
    v_mfma_f32_16x16x32_bf16 v[68:71], v[164:167], v[176:179], v[68:71]
    ds_read_b64_tr_b16 v[138:139], v4 offset:53248
    s_waitcnt lgkmcnt(6)
    v_mfma_f32_16x16x32_bf16 v[84:87], v[132:135], v[148:151], v[84:87]
    ds_read_b64_tr_b16 v[168:169], v4 offset:57344
    v_mfma_f32_16x16x32_bf16 v[84:87], v[164:167], v[180:183], v[84:87]
    ds_read_b64_tr_b16 v[170:171], v4 offset:61440
    v_mfma_f32_16x16x32_bf16 v[80:83], v[128:131], v[148:151], v[80:83]
    ds_read_b64_tr_b16 v[140:141], v5 offset:49152
    v_mfma_f32_16x16x32_bf16 v[80:83], v[160:163], v[180:183], v[80:83]
    ds_read_b64_tr_b16 v[142:143], v5 offset:53248
    s_waitcnt lgkmcnt(8)
    v_mfma_f32_16x16x32_bf16 v[96:99], v[128:131], v[152:155], v[96:99]
    ds_read_b64_tr_b16 v[172:173], v5 offset:57344
    v_mfma_f32_16x16x32_bf16 v[96:99], v[160:163], v[184:187], v[96:99]
    ds_read_b64_tr_b16 v[174:175], v5 offset:61440
    v_mfma_f32_16x16x32_bf16 v[100:103], v[132:135], v[152:155], v[100:103]
    v_mfma_f32_16x16x32_bf16 v[100:103], v[164:167], v[184:187], v[100:103]
    s_waitcnt lgkmcnt(8)
    v_mfma_f32_16x16x32_bf16 v[116:119], v[132:135], v[156:159], v[116:119]
    s_sub_u32 s55, s55, 1
    v_mfma_f32_16x16x32_bf16 v[116:119], v[164:167], v[188:191], v[116:119]
    s_cmp_lg_u32 s55, 0
    v_mfma_f32_16x16x32_bf16 v[112:115], v[128:131], v[156:159], v[112:115]
    v_mfma_f32_16x16x32_bf16 v[112:115], v[160:163], v[188:191], v[112:115]
    s_cbranch_scc1 g2loop_50
    s_waitcnt lgkmcnt(0)
    s_barrier
    v_mfma_f32_16x16x32_bf16 v[72:75], v[136:139], v[144:147], v[72:75]
    ds_read_b64_tr_b16 v[192:193], v2 offset:0
    ds_read_b64_tr_b16 v[194:195], v2 offset:4096
    v_mfma_f32_16x16x32_bf16 v[72:75], v[168:171], v[176:179], v[72:75]
    ds_read_b128 v[208:211], v7 offset:0
    ds_read_b128 v[212:215], v7 offset:1024
    v_mfma_f32_16x16x32_bf16 v[76:79], v[140:143], v[144:147], v[76:79]
    ds_read_b64_tr_b16 v[196:197], v3 offset:0
    ds_read_b64_tr_b16 v[198:199], v3 offset:4096
    v_mfma_f32_16x16x32_bf16 v[76:79], v[172:175], v[176:179], v[76:79]
    ds_read_b64_tr_b16 v[200:201], v4 offset:0
    ds_read_b64_tr_b16 v[202:203], v4 offset:4096
    v_mfma_f32_16x16x32_bf16 v[92:95], v[140:143], v[148:151], v[92:95]
    ds_read_b64_tr_b16 v[204:205], v5 offset:0
    ds_read_b64_tr_b16 v[206:207], v5 offset:4096
    v_mfma_f32_16x16x32_bf16 v[92:95], v[172:175], v[180:183], v[92:95]
    ds_read_b64_tr_b16 v[216:217], v2 offset:8192
    ds_read_b64_tr_b16 v[218:219], v2 offset:12288
    v_mfma_f32_16x16x32_bf16 v[88:91], v[136:139], v[148:151], v[88:91]
    ds_read_b128 v[232:235], v7 offset:8192
    ds_read_b128 v[236:239], v7 offset:9216
    v_mfma_f32_16x16x32_bf16 v[88:91], v[168:171], v[180:183], v[88:91]
    ds_read_b64_tr_b16 v[220:221], v3 offset:8192
    v_mfma_f32_16x16x32_bf16 v[104:107], v[136:139], v[152:155], v[104:107]
    ds_read_b64_tr_b16 v[222:223], v3 offset:12288
    v_mfma_f32_16x16x32_bf16 v[104:107], v[168:171], v[184:187], v[104:107]
    ds_read_b64_tr_b16 v[224:225], v4 offset:8192
    v_mfma_f32_16x16x32_bf16 v[108:111], v[140:143], v[152:155], v[108:111]
    ds_read_b64_tr_b16 v[226:227], v4 offset:12288
    v_mfma_f32_16x16x32_bf16 v[108:111], v[172:175], v[184:187], v[108:111]
    ds_read_b64_tr_b16 v[228:229], v5 offset:8192
    v_mfma_f32_16x16x32_bf16 v[124:127], v[140:143], v[156:159], v[124:127]
    ds_read_b64_tr_b16 v[230:231], v5 offset:12288
    v_mfma_f32_16x16x32_bf16 v[124:127], v[172:175], v[188:191], v[124:127]
    v_mov_b32 v12, 26
    v_mfma_f32_16x16x32_bf16 v[120:123], v[136:139], v[156:159], v[120:123]
    ds_read_b32 v22, v18 offset:16
    v_mfma_f32_16x16x32_bf16 v[120:123], v[168:171], v[188:191], v[120:123]
    s_waitcnt lgkmcnt(0)
    s_mov_b64 exec, 1
    ds_write_b32 v11, v12
    s_mov_b64 exec, -1
    v_cmp_gt_u32 vcc, 26, v22
    v_mfma_f32_16x16x32_bf16 v[96:99], v[192:195], v[208:211], v[96:99]
    s_cbranch_vccnz sl_63
bk_65:
    ds_read_b64_tr_b16 v[128:129], v2 offset:16384
    ds_read_b64_tr_b16 v[130:131], v2 offset:20480
    v_mfma_f32_16x16x32_bf16 v[96:99], v[216:219], v[232:235], v[96:99]
    ds_read_b128 v[144:147], v7 offset:16384
    ds_read_b128 v[148:151], v7 offset:17408
    v_mfma_f32_16x16x32_bf16 v[112:115], v[192:195], v[212:215], v[112:115]
    ds_read_b64_tr_b16 v[132:133], v3 offset:16384
    ds_read_b64_tr_b16 v[134:135], v3 offset:20480
    v_mfma_f32_16x16x32_bf16 v[112:115], v[216:219], v[236:239], v[112:115]
    ds_read_b64_tr_b16 v[136:137], v4 offset:16384
    ds_read_b64_tr_b16 v[138:139], v4 offset:20480
    v_mfma_f32_16x16x32_bf16 v[116:119], v[196:199], v[212:215], v[116:119]
    ds_read_b64_tr_b16 v[140:141], v5 offset:16384
    ds_read_b64_tr_b16 v[142:143], v5 offset:20480
    v_mfma_f32_16x16x32_bf16 v[116:119], v[220:223], v[236:239], v[116:119]
    ds_read_b64_tr_b16 v[152:153], v2 offset:24576
    ds_read_b64_tr_b16 v[154:155], v2 offset:28672
    v_mfma_f32_16x16x32_bf16 v[100:103], v[196:199], v[208:211], v[100:103]
    ds_read_b128 v[168:171], v7 offset:24576
    ds_read_b128 v[172:175], v7 offset:25600
    v_mfma_f32_16x16x32_bf16 v[100:103], v[220:223], v[232:235], v[100:103]
    ds_read_b64_tr_b16 v[156:157], v3 offset:24576
    v_mfma_f32_16x16x32_bf16 v[104:107], v[200:203], v[208:211], v[104:107]
    ds_read_b64_tr_b16 v[158:159], v3 offset:28672
    v_mfma_f32_16x16x32_bf16 v[104:107], v[224:227], v[232:235], v[104:107]
    ds_read_b64_tr_b16 v[160:161], v4 offset:24576
    v_mfma_f32_16x16x32_bf16 v[120:123], v[200:203], v[212:215], v[120:123]
    ds_read_b64_tr_b16 v[162:163], v4 offset:28672
    v_mfma_f32_16x16x32_bf16 v[120:123], v[224:227], v[236:239], v[120:123]
    ds_read_b64_tr_b16 v[164:165], v5 offset:24576
    v_mfma_f32_16x16x32_bf16 v[124:127], v[204:207], v[212:215], v[124:127]
    ds_read_b64_tr_b16 v[166:167], v5 offset:28672
    v_mfma_f32_16x16x32_bf16 v[124:127], v[228:231], v[236:239], v[124:127]
    v_mov_b32 v12, 27
    v_mfma_f32_16x16x32_bf16 v[108:111], v[204:207], v[208:211], v[108:111]
    ds_read_b32 v22, v18 offset:16
    v_mfma_f32_16x16x32_bf16 v[108:111], v[228:231], v[232:235], v[108:111]
    s_waitcnt lgkmcnt(0)
    s_mov_b64 exec, 1
    ds_write_b32 v11, v12
    s_mov_b64 exec, -1
    v_cmp_gt_u32 vcc, 27, v22
    v_mfma_f32_16x16x32_bf16 v[96:99], v[128:131], v[144:147], v[96:99]
    s_cbranch_vccnz sl_66
bk_68:
    ds_read_b64_tr_b16 v[192:193], v2 offset:32768
    ds_read_b64_tr_b16 v[194:195], v2 offset:36864
    v_mfma_f32_16x16x32_bf16 v[96:99], v[152:155], v[168:171], v[96:99]
    ds_read_b128 v[208:211], v7 offset:32768
    ds_read_b128 v[212:215], v7 offset:33792
    v_mfma_f32_16x16x32_bf16 v[112:115], v[128:131], v[148:151], v[112:115]
    ds_read_b64_tr_b16 v[196:197], v3 offset:32768
    ds_read_b64_tr_b16 v[198:199], v3 offset:36864
    v_mfma_f32_16x16x32_bf16 v[112:115], v[152:155], v[172:175], v[112:115]
    ds_read_b64_tr_b16 v[200:201], v4 offset:32768
    ds_read_b64_tr_b16 v[202:203], v4 offset:36864
    v_mfma_f32_16x16x32_bf16 v[116:119], v[132:135], v[148:151], v[116:119]
    ds_read_b64_tr_b16 v[204:205], v5 offset:32768
    ds_read_b64_tr_b16 v[206:207], v5 offset:36864
    v_mfma_f32_16x16x32_bf16 v[116:119], v[156:159], v[172:175], v[116:119]
    ds_read_b64_tr_b16 v[216:217], v2 offset:40960
    ds_read_b64_tr_b16 v[218:219], v2 offset:45056
    v_mfma_f32_16x16x32_bf16 v[100:103], v[132:135], v[144:147], v[100:103]
    ds_read_b128 v[232:235], v7 offset:40960
    ds_read_b128 v[236:239], v7 offset:41984
    v_mfma_f32_16x16x32_bf16 v[100:103], v[156:159], v[168:171], v[100:103]
    ds_read_b64_tr_b16 v[220:221], v3 offset:40960
    v_mfma_f32_16x16x32_bf16 v[104:107], v[136:139], v[144:147], v[104:107]
    ds_read_b64_tr_b16 v[222:223], v3 offset:45056
    v_mfma_f32_16x16x32_bf16 v[104:107], v[160:163], v[168:171], v[104:107]
    ds_read_b64_tr_b16 v[224:225], v4 offset:40960
    v_mfma_f32_16x16x32_bf16 v[120:123], v[136:139], v[148:151], v[120:123]
    ds_read_b64_tr_b16 v[226:227], v4 offset:45056
    v_mfma_f32_16x16x32_bf16 v[120:123], v[160:163], v[172:175], v[120:123]
    ds_read_b64_tr_b16 v[228:229], v5 offset:40960
    v_mfma_f32_16x16x32_bf16 v[124:127], v[140:143], v[148:151], v[124:127]
    ds_read_b64_tr_b16 v[230:231], v5 offset:45056
    v_mfma_f32_16x16x32_bf16 v[124:127], v[164:167], v[172:175], v[124:127]
    v_mov_b32 v12, 28
    v_mfma_f32_16x16x32_bf16 v[108:111], v[140:143], v[144:147], v[108:111]
    ds_read_b32 v22, v18 offset:16
    v_mfma_f32_16x16x32_bf16 v[108:111], v[164:167], v[168:171], v[108:111]
    s_waitcnt lgkmcnt(0)
    s_mov_b64 exec, 1
    ds_write_b32 v11, v12
    s_mov_b64 exec, -1
    v_cmp_gt_u32 vcc, 28, v22
    v_mfma_f32_16x16x32_bf16 v[96:99], v[192:195], v[208:211], v[96:99]
    s_cbranch_vccnz sl_69
bk_71:
    ds_read_b64_tr_b16 v[128:129], v2 offset:49152
    ds_read_b64_tr_b16 v[130:131], v2 offset:53248
    v_mfma_f32_16x16x32_bf16 v[96:99], v[216:219], v[232:235], v[96:99]
    ds_read_b128 v[144:147], v7 offset:49152
    ds_read_b128 v[148:151], v7 offset:50176
    v_mfma_f32_16x16x32_bf16 v[112:115], v[192:195], v[212:215], v[112:115]
    ds_read_b64_tr_b16 v[132:133], v3 offset:49152
    ds_read_b64_tr_b16 v[134:135], v3 offset:53248
    v_mfma_f32_16x16x32_bf16 v[112:115], v[216:219], v[236:239], v[112:115]
    ds_read_b64_tr_b16 v[136:137], v4 offset:49152
    ds_read_b64_tr_b16 v[138:139], v4 offset:53248
    v_mfma_f32_16x16x32_bf16 v[116:119], v[196:199], v[212:215], v[116:119]
    ds_read_b64_tr_b16 v[140:141], v5 offset:49152
    ds_read_b64_tr_b16 v[142:143], v5 offset:53248
    v_mfma_f32_16x16x32_bf16 v[116:119], v[220:223], v[236:239], v[116:119]
    ds_read_b64_tr_b16 v[152:153], v2 offset:57344
    ds_read_b64_tr_b16 v[154:155], v2 offset:61440
    v_mfma_f32_16x16x32_bf16 v[100:103], v[196:199], v[208:211], v[100:103]
    ds_read_b128 v[168:171], v7 offset:57344
    ds_read_b128 v[172:175], v7 offset:58368
    v_mfma_f32_16x16x32_bf16 v[100:103], v[220:223], v[232:235], v[100:103]
    ds_read_b64_tr_b16 v[156:157], v3 offset:57344
    v_mfma_f32_16x16x32_bf16 v[104:107], v[200:203], v[208:211], v[104:107]
    ds_read_b64_tr_b16 v[158:159], v3 offset:61440
    v_mfma_f32_16x16x32_bf16 v[104:107], v[224:227], v[232:235], v[104:107]
    ds_read_b64_tr_b16 v[160:161], v4 offset:57344
    v_mfma_f32_16x16x32_bf16 v[120:123], v[200:203], v[212:215], v[120:123]
    ds_read_b64_tr_b16 v[162:163], v4 offset:61440
    v_mfma_f32_16x16x32_bf16 v[120:123], v[224:227], v[236:239], v[120:123]
    ds_read_b64_tr_b16 v[164:165], v5 offset:57344
    v_mfma_f32_16x16x32_bf16 v[124:127], v[204:207], v[212:215], v[124:127]
    ds_read_b64_tr_b16 v[166:167], v5 offset:61440
    v_mfma_f32_16x16x32_bf16 v[124:127], v[228:231], v[236:239], v[124:127]
    v_mov_b32 v12, 29
    v_mfma_f32_16x16x32_bf16 v[108:111], v[204:207], v[208:211], v[108:111]
    ds_read_b32 v22, v18 offset:16
    v_mfma_f32_16x16x32_bf16 v[108:111], v[228:231], v[232:235], v[108:111]
    s_waitcnt lgkmcnt(0)
    s_mov_b64 exec, 1
    ds_write_b32 v11, v12
    s_mov_b64 exec, -1
    v_cmp_gt_u32 vcc, 29, v22
    v_mfma_f32_16x16x32_bf16 v[96:99], v[128:131], v[144:147], v[96:99]
    s_cbranch_vccnz sl_72
bk_74:
    ds_read_b64_tr_b16 v[192:193], v2 offset:0
    ds_read_b64_tr_b16 v[194:195], v2 offset:4096
    v_mfma_f32_16x16x32_bf16 v[96:99], v[152:155], v[168:171], v[96:99]
    ds_read_b128 v[208:211], v6 offset:0
    ds_read_b128 v[212:215], v6 offset:1024
    v_mfma_f32_16x16x32_bf16 v[112:115], v[128:131], v[148:151], v[112:115]
    ds_read_b64_tr_b16 v[196:197], v3 offset:0
    ds_read_b64_tr_b16 v[198:199], v3 offset:4096
    v_mfma_f32_16x16x32_bf16 v[112:115], v[152:155], v[172:175], v[112:115]
    ds_read_b64_tr_b16 v[200:201], v4 offset:0
    ds_read_b64_tr_b16 v[202:203], v4 offset:4096
    v_mfma_f32_16x16x32_bf16 v[116:119], v[132:135], v[148:151], v[116:119]
    ds_read_b64_tr_b16 v[204:205], v5 offset:0
    ds_read_b64_tr_b16 v[206:207], v5 offset:4096
    v_mfma_f32_16x16x32_bf16 v[116:119], v[156:159], v[172:175], v[116:119]
    ds_read_b64_tr_b16 v[216:217], v2 offset:8192
    ds_read_b64_tr_b16 v[218:219], v2 offset:12288
    v_mfma_f32_16x16x32_bf16 v[100:103], v[132:135], v[144:147], v[100:103]
    ds_read_b128 v[232:235], v6 offset:8192
    ds_read_b128 v[236:239], v6 offset:9216
    v_mfma_f32_16x16x32_bf16 v[100:103], v[156:159], v[168:171], v[100:103]
    ds_read_b64_tr_b16 v[220:221], v3 offset:8192
    v_mfma_f32_16x16x32_bf16 v[104:107], v[136:139], v[144:147], v[104:107]
    ds_read_b64_tr_b16 v[222:223], v3 offset:12288
    v_mfma_f32_16x16x32_bf16 v[104:107], v[160:163], v[168:171], v[104:107]
    ds_read_b64_tr_b16 v[224:225], v4 offset:8192
    v_mfma_f32_16x16x32_bf16 v[120:123], v[136:139], v[148:151], v[120:123]
    ds_read_b64_tr_b16 v[226:227], v4 offset:12288
    v_mfma_f32_16x16x32_bf16 v[120:123], v[160:163], v[172:175], v[120:123]
    ds_read_b64_tr_b16 v[228:229], v5 offset:8192
    v_mfma_f32_16x16x32_bf16 v[124:127], v[140:143], v[148:151], v[124:127]
    ds_read_b64_tr_b16 v[230:231], v5 offset:12288
    v_mfma_f32_16x16x32_bf16 v[124:127], v[164:167], v[172:175], v[124:127]
    v_mov_b32 v12, 30
    v_mfma_f32_16x16x32_bf16 v[108:111], v[140:143], v[144:147], v[108:111]
    ds_read_b32 v22, v18 offset:16
    v_mfma_f32_16x16x32_bf16 v[108:111], v[164:167], v[168:171], v[108:111]
    s_waitcnt lgkmcnt(0)
    s_mov_b64 exec, 1
    ds_write_b32 v11, v12
    s_mov_b64 exec, -1
    v_cmp_gt_u32 vcc, 30, v22
    v_mfma_f32_16x16x32_bf16 v[64:67], v[192:195], v[208:211], v[64:67]
    s_cbranch_vccnz sl_75
bk_77:
    ds_read_b64_tr_b16 v[128:129], v2 offset:16384
    ds_read_b64_tr_b16 v[130:131], v2 offset:20480
    v_cvt_pk_bf16_f32 v240, v96, v97
    v_cvt_pk_bf16_f32 v241, v98, v99
    v_mfma_f32_16x16x32_bf16 v[64:67], v[216:219], v[232:235], v[64:67]
    ds_read_b128 v[144:147], v6 offset:16384
    ds_read_b128 v[148:151], v6 offset:17408
    v_cvt_pk_bf16_f32 v242, v100, v101
    v_and_b32 v240, -2, v240
    v_cvt_pk_bf16_f32 v243, v102, v103
    v_and_b32 v242, -2, v242
    buffer_store_dwordx4 v[240:243], v17, s[4:7], s41 offen offset:0 sc1
    v_mfma_f32_16x16x32_bf16 v[80:83], v[192:195], v[212:215], v[80:83]
    ds_read_b64_tr_b16 v[132:133], v3 offset:16384
    ds_read_b64_tr_b16 v[134:135], v3 offset:20480
    v_cvt_pk_bf16_f32 v248, v112, v113
    v_cvt_pk_bf16_f32 v249, v114, v115
    v_mfma_f32_16x16x32_bf16 v[80:83], v[216:219], v[236:239], v[80:83]
    ds_read_b64_tr_b16 v[136:137], v4 offset:16384
    ds_read_b64_tr_b16 v[138:139], v4 offset:20480
    v_cvt_pk_bf16_f32 v250, v116, v117
    v_and_b32 v248, -2, v248
    v_cvt_pk_bf16_f32 v251, v118, v119
    v_and_b32 v250, -2, v250
    buffer_store_dwordx4 v[248:251], v17, s[4:7], s41 offen offset:2048 sc1
    v_mfma_f32_16x16x32_bf16 v[84:87], v[196:199], v[212:215], v[84:87]
    ds_read_b64_tr_b16 v[140:141], v5 offset:16384
    ds_read_b64_tr_b16 v[142:143], v5 offset:20480
    v_cvt_pk_bf16_f32 v252, v120, v121
    v_cvt_pk_bf16_f32 v253, v122, v123
    v_mfma_f32_16x16x32_bf16 v[84:87], v[220:223], v[236:239], v[84:87]
    ds_read_b64_tr_b16 v[152:153], v2 offset:24576
    ds_read_b64_tr_b16 v[154:155], v2 offset:28672
    v_cvt_pk_bf16_f32 v254, v124, v125
    v_and_b32 v252, -2, v252
    v_cvt_pk_bf16_f32 v255, v126, v127
    v_and_b32 v254, -2, v254
    buffer_store_dwordx4 v[252:255], v17, s[4:7], s41 offen offset:3072 sc1
    v_mfma_f32_16x16x32_bf16 v[68:71], v[196:199], v[208:211], v[68:71]
    ds_read_b128 v[168:171], v6 offset:24576
    ds_read_b128 v[172:175], v6 offset:25600
    v_cvt_pk_bf16_f32 v244, v104, v105
    v_cvt_pk_bf16_f32 v245, v106, v107
    v_mfma_f32_16x16x32_bf16 v[68:71], v[220:223], v[232:235], v[68:71]
    ds_read_b64_tr_b16 v[156:157], v3 offset:24576
    v_cvt_pk_bf16_f32 v246, v108, v109
    v_and_b32 v244, -2, v244
    v_cvt_pk_bf16_f32 v247, v110, v111
    v_and_b32 v246, -2, v246
    buffer_store_dwordx4 v[244:247], v17, s[4:7], s41 offen offset:1024 sc1
    v_mfma_f32_16x16x32_bf16 v[72:75], v[200:203], v[208:211], v[72:75]
    ds_read_b64_tr_b16 v[158:159], v3 offset:28672
    v_mfma_f32_16x16x32_bf16 v[72:75], v[224:227], v[232:235], v[72:75]
    ds_read_b64_tr_b16 v[160:161], v4 offset:24576
    v_mfma_f32_16x16x32_bf16 v[88:91], v[200:203], v[212:215], v[88:91]
    ds_read_b64_tr_b16 v[162:163], v4 offset:28672
    v_mfma_f32_16x16x32_bf16 v[88:91], v[224:227], v[236:239], v[88:91]
    ds_read_b64_tr_b16 v[164:165], v5 offset:24576
    v_mfma_f32_16x16x32_bf16 v[92:95], v[204:207], v[212:215], v[92:95]
    ds_read_b64_tr_b16 v[166:167], v5 offset:28672
    v_mfma_f32_16x16x32_bf16 v[92:95], v[228:231], v[236:239], v[92:95]
    v_mov_b32 v12, 31
    v_mfma_f32_16x16x32_bf16 v[76:79], v[204:207], v[208:211], v[76:79]
    ds_read_b32 v22, v18 offset:16
    v_mfma_f32_16x16x32_bf16 v[76:79], v[228:231], v[232:235], v[76:79]
    s_waitcnt lgkmcnt(0)
    s_mov_b64 exec, 1
    ds_write_b32 v11, v12
    s_mov_b64 exec, -1
    v_cmp_gt_u32 vcc, 31, v22
    v_mfma_f32_16x16x32_bf16 v[64:67], v[128:131], v[144:147], v[64:67]
    s_cbranch_vccnz sl_78
bk_80:
    ds_read_b64_tr_b16 v[192:193], v2 offset:32768
    ds_read_b64_tr_b16 v[194:195], v2 offset:36864
    v_mfma_f32_16x16x32_bf16 v[64:67], v[152:155], v[168:171], v[64:67]
    ds_read_b128 v[208:211], v6 offset:32768
    ds_read_b128 v[212:215], v6 offset:33792
    v_mfma_f32_16x16x32_bf16 v[80:83], v[128:131], v[148:151], v[80:83]
    ds_read_b64_tr_b16 v[196:197], v3 offset:32768
    ds_read_b64_tr_b16 v[198:199], v3 offset:36864
    v_mfma_f32_16x16x32_bf16 v[80:83], v[152:155], v[172:175], v[80:83]
    ds_read_b64_tr_b16 v[200:201], v4 offset:32768
    ds_read_b64_tr_b16 v[202:203], v4 offset:36864
    v_mfma_f32_16x16x32_bf16 v[84:87], v[132:135], v[148:151], v[84:87]
    ds_read_b64_tr_b16 v[204:205], v5 offset:32768
    ds_read_b64_tr_b16 v[206:207], v5 offset:36864
    v_mfma_f32_16x16x32_bf16 v[84:87], v[156:159], v[172:175], v[84:87]
    ds_read_b64_tr_b16 v[216:217], v2 offset:40960
    ds_read_b64_tr_b16 v[218:219], v2 offset:45056
    v_mfma_f32_16x16x32_bf16 v[68:71], v[132:135], v[144:147], v[68:71]
    ds_read_b128 v[232:235], v6 offset:40960
    ds_read_b128 v[236:239], v6 offset:41984
    v_mfma_f32_16x16x32_bf16 v[68:71], v[156:159], v[168:171], v[68:71]
    ds_read_b64_tr_b16 v[220:221], v3 offset:40960
    v_mfma_f32_16x16x32_bf16 v[72:75], v[136:139], v[144:147], v[72:75]
    ds_read_b64_tr_b16 v[222:223], v3 offset:45056
    v_mfma_f32_16x16x32_bf16 v[72:75], v[160:163], v[168:171], v[72:75]
    ds_read_b64_tr_b16 v[224:225], v4 offset:40960
    v_mfma_f32_16x16x32_bf16 v[88:91], v[136:139], v[148:151], v[88:91]
    ds_read_b64_tr_b16 v[226:227], v4 offset:45056
    v_mfma_f32_16x16x32_bf16 v[88:91], v[160:163], v[172:175], v[88:91]
    ds_read_b64_tr_b16 v[228:229], v5 offset:40960
    v_mfma_f32_16x16x32_bf16 v[92:95], v[140:143], v[148:151], v[92:95]
    ds_read_b64_tr_b16 v[230:231], v5 offset:45056
    v_mfma_f32_16x16x32_bf16 v[92:95], v[164:167], v[172:175], v[92:95]
    v_mov_b32 v12, 32
    v_mfma_f32_16x16x32_bf16 v[76:79], v[140:143], v[144:147], v[76:79]
    ds_read_b32 v22, v18 offset:16
    v_mfma_f32_16x16x32_bf16 v[76:79], v[164:167], v[168:171], v[76:79]
    s_waitcnt lgkmcnt(0)
    s_mov_b64 exec, 1
    ds_write_b32 v11, v12
    s_mov_b64 exec, -1
    v_cmp_gt_u32 vcc, 60, v22
    v_mfma_f32_16x16x32_bf16 v[64:67], v[192:195], v[208:211], v[64:67]
    s_cbranch_vccnz sl_81
bk_83:
    ds_read_b64_tr_b16 v[128:129], v2 offset:49152
    ds_read_b64_tr_b16 v[130:131], v2 offset:53248
    ds_read_b128 v[144:147], v6 offset:49152
    v_mfma_f32_16x16x32_bf16 v[64:67], v[216:219], v[232:235], v[64:67]
    ds_read_b128 v[148:151], v6 offset:50176
    ds_read_b64_tr_b16 v[132:133], v3 offset:49152
    ds_read_b64_tr_b16 v[134:135], v3 offset:53248
    v_mfma_f32_16x16x32_bf16 v[80:83], v[192:195], v[212:215], v[80:83]
    ds_read_b64_tr_b16 v[136:137], v4 offset:49152
    ds_read_b64_tr_b16 v[138:139], v4 offset:53248
    v_mfma_f32_16x16x32_bf16 v[80:83], v[216:219], v[236:239], v[80:83]
    ds_read_b64_tr_b16 v[140:141], v5 offset:49152
    ds_read_b64_tr_b16 v[142:143], v5 offset:53248
    v_mfma_f32_16x16x32_bf16 v[84:87], v[196:199], v[212:215], v[84:87]
    ds_read_b64_tr_b16 v[152:153], v2 offset:57344
    ds_read_b64_tr_b16 v[154:155], v2 offset:61440
    buffer_load_dwordx4 v[176:179], v17, s[4:7], s40 offen offset:0 sc1
    v_mfma_f32_16x16x32_bf16 v[84:87], v[220:223], v[236:239], v[84:87]
    ds_read_b128 v[168:171], v6 offset:57344
    ds_read_b128 v[172:175], v6 offset:58368
    v_mfma_f32_16x16x32_bf16 v[68:71], v[196:199], v[208:211], v[68:71]
    ds_read_b64_tr_b16 v[156:157], v3 offset:57344
    ds_read_b64_tr_b16 v[158:159], v3 offset:61440
    v_mfma_f32_16x16x32_bf16 v[68:71], v[220:223], v[232:235], v[68:71]
    ds_read_b64_tr_b16 v[160:161], v4 offset:57344
    ds_read_b64_tr_b16 v[162:163], v4 offset:61440
    buffer_load_dwordx4 v[180:183], v17, s[4:7], s40 offen offset:1024 sc1
    v_mfma_f32_16x16x32_bf16 v[72:75], v[200:203], v[208:211], v[72:75]
    ds_read_b64_tr_b16 v[164:165], v5 offset:57344
    ds_read_b64_tr_b16 v[166:167], v5 offset:61440
    v_mfma_f32_16x16x32_bf16 v[72:75], v[224:227], v[232:235], v[72:75]
    ds_read_b64 v[28:29], v9 offset:0
    ds_read_b64 v[30:31], v9 offset:1024
    v_mfma_f32_16x16x32_bf16 v[88:91], v[200:203], v[212:215], v[88:91]
    ds_read_b64 v[32:33], v10 offset:0
    ds_read_b64 v[34:35], v10 offset:1024
    buffer_load_dwordx4 v[184:187], v17, s[4:7], s40 offen offset:2048 sc1
    v_mfma_f32_16x16x32_bf16 v[88:91], v[224:227], v[236:239], v[88:91]
    ds_read_b64 v[36:37], v9 offset:2048
    ds_read_b64 v[38:39], v9 offset:3072
    v_mfma_f32_16x16x32_bf16 v[92:95], v[204:207], v[212:215], v[92:95]
    ds_read_b64 v[40:41], v10 offset:2048
    ds_read_b64 v[42:43], v10 offset:3072
    v_mfma_f32_16x16x32_bf16 v[92:95], v[228:231], v[236:239], v[92:95]
    v_mov_b32 v12, 33
    buffer_load_dwordx4 v[188:191], v17, s[4:7], s40 offen offset:3072 sc1
    v_mfma_f32_16x16x32_bf16 v[76:79], v[204:207], v[208:211], v[76:79]
    ds_read_b32 v22, v18 offset:16
    v_mfma_f32_16x16x32_bf16 v[76:79], v[228:231], v[232:235], v[76:79]
    s_waitcnt lgkmcnt(0)
    s_mov_b64 exec, 1
    ds_write_b32 v11, v12
    s_mov_b64 exec, -1
    v_mfma_f32_16x16x32_bf16 v[64:67], v[128:131], v[144:147], v[64:67]
    v_lshlrev_b32 v96, 16, v28
    v_and_b32 v97, 0xffff0000, v28
    v_mfma_f32_16x16x32_bf16 v[64:67], v[152:155], v[168:171], v[64:67]
    v_lshlrev_b32 v98, 16, v29
    v_and_b32 v99, 0xffff0000, v29
    v_mfma_f32_16x16x32_bf16 v[80:83], v[128:131], v[148:151], v[80:83]
    v_lshlrev_b32 v100, 16, v30
    v_and_b32 v101, 0xffff0000, v30
    v_mfma_f32_16x16x32_bf16 v[80:83], v[152:155], v[172:175], v[80:83]
    v_lshlrev_b32 v102, 16, v31
    v_and_b32 v103, 0xffff0000, v31
    v_mfma_f32_16x16x32_bf16 v[84:87], v[132:135], v[148:151], v[84:87]
    v_lshlrev_b32 v104, 16, v32
    v_and_b32 v105, 0xffff0000, v32
    v_mfma_f32_16x16x32_bf16 v[84:87], v[156:159], v[172:175], v[84:87]
    v_lshlrev_b32 v106, 16, v33
    v_and_b32 v107, 0xffff0000, v33
    v_mfma_f32_16x16x32_bf16 v[68:71], v[132:135], v[144:147], v[68:71]
    v_lshlrev_b32 v108, 16, v34
    v_and_b32 v109, 0xffff0000, v34
    v_mfma_f32_16x16x32_bf16 v[68:71], v[156:159], v[168:171], v[68:71]
    v_lshlrev_b32 v110, 16, v35
    v_and_b32 v111, 0xffff0000, v35
    v_mfma_f32_16x16x32_bf16 v[72:75], v[136:139], v[144:147], v[72:75]
    v_lshlrev_b32 v112, 16, v36
    v_and_b32 v113, 0xffff0000, v36
    v_mfma_f32_16x16x32_bf16 v[72:75], v[160:163], v[168:171], v[72:75]
    v_lshlrev_b32 v114, 16, v37
    v_and_b32 v115, 0xffff0000, v37
    v_mfma_f32_16x16x32_bf16 v[88:91], v[136:139], v[148:151], v[88:91]
    v_lshlrev_b32 v116, 16, v38
    v_and_b32 v117, 0xffff0000, v38
    v_mfma_f32_16x16x32_bf16 v[88:91], v[160:163], v[172:175], v[88:91]
    v_lshlrev_b32 v118, 16, v39
    v_and_b32 v119, 0xffff0000, v39
    v_mfma_f32_16x16x32_bf16 v[92:95], v[140:143], v[148:151], v[92:95]
    v_lshlrev_b32 v120, 16, v40
    v_and_b32 v121, 0xffff0000, v40
    v_mfma_f32_16x16x32_bf16 v[92:95], v[164:167], v[172:175], v[92:95]
    v_lshlrev_b32 v122, 16, v41
    v_and_b32 v123, 0xffff0000, v41
    v_mfma_f32_16x16x32_bf16 v[76:79], v[140:143], v[144:147], v[76:79]
    v_lshlrev_b32 v124, 16, v42
    v_and_b32 v125, 0xffff0000, v42
    v_mfma_f32_16x16x32_bf16 v[76:79], v[164:167], v[168:171], v[76:79]
    v_lshlrev_b32 v126, 16, v43
    v_and_b32 v127, 0xffff0000, v43
    v_mov_b32 v52, 0x35800000
    v_mov_b32 v53, 0x35800000
    v_pk_fma_f32 v[64:65], v[96:97], v[52:53], v[64:65]
    v_pk_fma_f32 v[66:67], v[98:99], v[52:53], v[66:67]
    v_pk_fma_f32 v[80:81], v[112:113], v[52:53], v[80:81]
    v_pk_fma_f32 v[82:83], v[114:115], v[52:53], v[82:83]
    v_pk_fma_f32 v[84:85], v[116:117], v[52:53], v[84:85]
    v_pk_fma_f32 v[86:87], v[118:119], v[52:53], v[86:87]
    v_pk_fma_f32 v[68:69], v[100:101], v[52:53], v[68:69]
    v_pk_fma_f32 v[70:71], v[102:103], v[52:53], v[70:71]
    v_pk_fma_f32 v[72:73], v[104:105], v[52:53], v[72:73]
    v_pk_fma_f32 v[74:75], v[106:107], v[52:53], v[74:75]
    v_pk_fma_f32 v[88:89], v[120:121], v[52:53], v[88:89]
    v_pk_fma_f32 v[90:91], v[122:123], v[52:53], v[90:91]
    v_pk_fma_f32 v[92:93], v[124:125], v[52:53], v[92:93]
    v_pk_fma_f32 v[94:95], v[126:127], v[52:53], v[94:95]
    v_pk_fma_f32 v[76:77], v[108:109], v[52:53], v[76:77]
    v_pk_fma_f32 v[78:79], v[110:111], v[52:53], v[78:79]
    buffer_load_dwordx4 v[192:195], v17, s[4:7], s40 offen offset:0 sc1
    buffer_load_dwordx4 v[196:199], v17, s[4:7], s40 offen offset:1024 sc1
    buffer_load_dwordx4 v[200:203], v17, s[4:7], s40 offen offset:2048 sc1
    buffer_load_dwordx4 v[204:207], v17, s[4:7], s40 offen offset:3072 sc1
    s_waitcnt vmcnt(4)
    v_or3_b32 v44, v176, v178, v180
    v_or3_b32 v45, v182, v184, v186
    v_or3_b32 v44, v44, v188, v190
    v_or_b32 v44, v44, v45
    v_and_b32 v44, 1, v44
    v_cmp_ne_u32 vcc, 0, v44
    s_cbranch_vccnz pe_84
oke_85:
    v_lshlrev_b32 v44, 16, v176
    v_and_b32 v45, 0xffff0000, v176
    v_pk_add_f32 v[64:65], v[64:65], v[44:45]
    v_lshlrev_b32 v46, 16, v177
    v_and_b32 v47, 0xffff0000, v177
    v_pk_add_f32 v[66:67], v[66:67], v[46:47]
    v_lshlrev_b32 v48, 16, v178
    v_and_b32 v49, 0xffff0000, v178
    v_pk_add_f32 v[68:69], v[68:69], v[48:49]
    v_lshlrev_b32_e64 v50, 16, v179
    v_and_b32 v51, 0xffff0000, v179
    v_pk_add_f32 v[70:71], v[70:71], v[50:51]
    v_cvt_pk_bf16_f32 v240, v64, v65
    v_cvt_pk_bf16_f32 v241, v66, v67
    v_cvt_pk_bf16_f32 v242, v68, v69
    v_cvt_pk_bf16_f32 v243, v70, v71
    s_nop 0
    v_permlane16_swap_b32 v240, v242
    v_permlane16_swap_b32 v241, v243
    buffer_store_dwordx4 v[240:243], v8, s[24:27], s42 offen offset:0 sc1
    v_lshlrev_b32 v44, 16, v180
    v_and_b32 v45, 0xffff0000, v180
    v_pk_add_f32 v[72:73], v[72:73], v[44:45]
    v_lshlrev_b32 v46, 16, v181
    v_and_b32 v47, 0xffff0000, v181
    v_pk_add_f32 v[74:75], v[74:75], v[46:47]
    v_lshlrev_b32 v48, 16, v182
    v_and_b32 v49, 0xffff0000, v182
    v_pk_add_f32 v[76:77], v[76:77], v[48:49]
    v_lshlrev_b32 v50, 16, v183
    v_and_b32 v51, 0xffff0000, v183
    v_pk_add_f32 v[78:79], v[78:79], v[50:51]
    v_cvt_pk_bf16_f32 v244, v72, v73
    v_cvt_pk_bf16_f32 v245, v74, v75
    v_cvt_pk_bf16_f32 v246, v76, v77
    v_cvt_pk_bf16_f32 v247, v78, v79
    s_nop 0
    v_permlane16_swap_b32 v244, v246
    v_permlane16_swap_b32 v245, v247
    buffer_store_dwordx4 v[244:247], v8, s[24:27], s42 offen offset:64 sc1
    v_lshlrev_b32 v44, 16, v184
    v_and_b32 v45, 0xffff0000, v184
    v_pk_add_f32 v[80:81], v[80:81], v[44:45]
    v_lshlrev_b32 v46, 16, v185
    v_and_b32 v47, 0xffff0000, v185
    v_pk_add_f32 v[82:83], v[82:83], v[46:47]
    v_lshlrev_b32 v48, 16, v186
    v_and_b32 v49, 0xffff0000, v186
    v_pk_add_f32 v[84:85], v[84:85], v[48:49]
    v_lshlrev_b32 v50, 16, v187
    v_and_b32 v51, 0xffff0000, v187
    v_pk_add_f32 v[86:87], v[86:87], v[50:51]
    v_cvt_pk_bf16_f32 v248, v80, v81
    v_cvt_pk_bf16_f32 v249, v82, v83
    v_cvt_pk_bf16_f32 v250, v84, v85
    v_cvt_pk_bf16_f32 v251, v86, v87
    s_add_u32 s42, s42, 32768
    v_permlane16_swap_b32 v248, v250
    v_permlane16_swap_b32 v249, v251
    buffer_store_dwordx4 v[248:251], v8, s[24:27], s42 offen offset:0 sc1
    v_lshlrev_b32 v44, 16, v188
    v_and_b32 v45, 0xffff0000, v188
    v_pk_add_f32 v[88:89], v[88:89], v[44:45]
    v_lshlrev_b32 v46, 16, v189
    v_and_b32 v47, 0xffff0000, v189
    v_pk_add_f32 v[90:91], v[90:91], v[46:47]
    v_lshlrev_b32 v48, 16, v190
    v_and_b32 v49, 0xffff0000, v190
    v_pk_add_f32 v[92:93], v[92:93], v[48:49]
    v_lshlrev_b32 v50, 16, v191
    v_and_b32 v51, 0xffff0000, v191
    v_pk_add_f32 v[94:95], v[94:95], v[50:51]
    v_cvt_pk_bf16_f32 v252, v88, v89
    v_cvt_pk_bf16_f32 v253, v90, v91
    v_cvt_pk_bf16_f32 v254, v92, v93
    v_cvt_pk_bf16_f32 v255, v94, v95
    s_nop 0
    v_permlane16_swap_b32 v252, v254
    v_permlane16_swap_b32 v253, v255
    buffer_store_dwordx4 v[252:255], v8, s[24:27], s42 offen offset:64 sc1
fin_87:
end_1:
    s_endpgm
sl_51:
    s_mov_b32 s54, 1000000
sp_52:
    ds_read_b32 v22, v18 offset:16
    s_waitcnt lgkmcnt(0)
    v_cmp_gt_u32 vcc, 2, v22
    s_cbranch_vccz bk_53
    s_sub_u32 s54, s54, 1
    s_cbranch_scc0 sp_52
    s_branch bk_53
sl_54:
    s_mov_b32 s54, 1000000
sp_55:
    ds_read_b32 v22, v18 offset:16
    s_waitcnt lgkmcnt(0)
    v_cmp_gt_u32 vcc, 3, v22
    s_cbranch_vccz bk_56
    s_sub_u32 s54, s54, 1
    s_cbranch_scc0 sp_55
    s_branch bk_56
sl_57:
    s_mov_b32 s54, 1000000
sp_58:
    ds_read_b32 v22, v18 offset:16
    s_waitcnt lgkmcnt(0)
    v_cmp_gt_u32 vcc, 4, v22
    s_cbranch_vccz bk_59
    s_sub_u32 s54, s54, 1
    s_cbranch_scc0 sp_58
    s_branch bk_59
sl_60:
    s_mov_b32 s54, 1000000
sp_61:
    ds_read_b32 v22, v18 offset:16
    s_waitcnt lgkmcnt(0)
    v_cmp_gt_u32 vcc, 5, v22
    s_cbranch_vccz bk_62
    s_sub_u32 s54, s54, 1
    s_cbranch_scc0 sp_61
    s_branch bk_62
sl_63:
    s_mov_b32 s54, 1000000
sp_64:
    ds_read_b32 v22, v18 offset:16
    s_waitcnt lgkmcnt(0)
    v_cmp_gt_u32 vcc, 26, v22
    s_cbranch_vccz bk_65
    s_sub_u32 s54, s54, 1
    s_cbranch_scc0 sp_64
    s_branch bk_65
sl_66:
    s_mov_b32 s54, 1000000
sp_67:
    ds_read_b32 v22, v18 offset:16
    s_waitcnt lgkmcnt(0)
    v_cmp_gt_u32 vcc, 27, v22
    s_cbranch_vccz bk_68
    s_sub_u32 s54, s54, 1
    s_cbranch_scc0 sp_67
    s_branch bk_68
sl_69:
    s_mov_b32 s54, 1000000
sp_70:
    ds_read_b32 v22, v18 offset:16
    s_waitcnt lgkmcnt(0)
    v_cmp_gt_u32 vcc, 28, v22
    s_cbranch_vccz bk_71
    s_sub_u32 s54, s54, 1
    s_cbranch_scc0 sp_70
    s_branch bk_71
sl_72:
    s_mov_b32 s54, 1000000
sp_73:
    ds_read_b32 v22, v18 offset:16
    s_waitcnt lgkmcnt(0)
    v_cmp_gt_u32 vcc, 29, v22
    s_cbranch_vccz bk_74
    s_sub_u32 s54, s54, 1
    s_cbranch_scc0 sp_73
    s_branch bk_74
sl_75:
    s_mov_b32 s54, 1000000
sp_76:
    ds_read_b32 v22, v18 offset:16
    s_waitcnt lgkmcnt(0)
    v_cmp_gt_u32 vcc, 30, v22
    s_cbranch_vccz bk_77
    s_sub_u32 s54, s54, 1
    s_cbranch_scc0 sp_76
    s_branch bk_77
sl_78:
    s_mov_b32 s54, 1000000
sp_79:
    ds_read_b32 v22, v18 offset:16
    s_waitcnt lgkmcnt(0)
    v_cmp_gt_u32 vcc, 31, v22
    s_cbranch_vccz bk_80
    s_sub_u32 s54, s54, 1
    s_cbranch_scc0 sp_79
    s_branch bk_80
sl_81:
    s_mov_b32 s54, 1000000
sp_82:
    ds_read_b32 v22, v18 offset:16
    s_waitcnt lgkmcnt(0)
    v_cmp_gt_u32 vcc, 60, v22
    s_cbranch_vccz bk_83
    s_sub_u32 s54, s54, 1
    s_cbranch_scc0 sp_82
    s_branch bk_83
pe_84:
    s_cbranch_execz end_1
    s_mov_b32 s54, 20000
pe2_88:
    s_sub_u32 s54, s54, 1
    s_cbranch_scc1 oke_85
    buffer_load_dwordx4 v[176:179], v17, s[4:7], s40 offen offset:0 sc1
    buffer_load_dwordx4 v[180:183], v17, s[4:7], s40 offen offset:1024 sc1
    buffer_load_dwordx4 v[184:187], v17, s[4:7], s40 offen offset:2048 sc1
    buffer_load_dwordx4 v[188:191], v17, s[4:7], s40 offen offset:3072 sc1
    s_waitcnt vmcnt(4)
    v_or3_b32 v44, v192, v194, v196
    v_or3_b32 v45, v198, v200, v202
    v_or3_b32 v44, v44, v204, v206
    v_or_b32 v44, v44, v45
    v_and_b32 v44, 1, v44
    v_cmp_ne_u32 vcc, 0, v44
    s_cbranch_vccz okb_86
    buffer_load_dwordx4 v[192:195], v17, s[4:7], s40 offen offset:0 sc1
    buffer_load_dwordx4 v[196:199], v17, s[4:7], s40 offen offset:1024 sc1
    buffer_load_dwordx4 v[200:203], v17, s[4:7], s40 offen offset:2048 sc1
    buffer_load_dwordx4 v[204:207], v17, s[4:7], s40 offen offset:3072 sc1
    s_waitcnt vmcnt(4)
    v_or3_b32 v44, v176, v178, v180
    v_or3_b32 v45, v182, v184, v186
    v_or3_b32 v44, v44, v188, v190
    v_or_b32 v44, v44, v45
    v_and_b32 v44, 1, v44
    v_cmp_ne_u32 vcc, 0, v44
    s_cbranch_vccz oke_85
    s_branch pe2_88
okb_86:
    v_lshlrev_b32 v44, 16, v192
    v_and_b32 v45, 0xffff0000, v192
    v_pk_add_f32 v[64:65], v[64:65], v[44:45]
    v_lshlrev_b32 v46, 16, v193
    v_and_b32 v47, 0xffff0000, v193
    v_pk_add_f32 v[66:67], v[66:67], v[46:47]
    v_lshlrev_b32 v48, 16, v194
    v_and_b32 v49, 0xffff0000, v194
    v_pk_add_f32 v[68:69], v[68:69], v[48:49]
    v_lshlrev_b32 v50, 16, v195
    v_and_b32 v51, 0xffff0000, v195
    v_pk_add_f32 v[70:71], v[70:71], v[50:51]
    v_cvt_pk_bf16_f32 v240, v64, v65
    v_cvt_pk_bf16_f32 v241, v66, v67
    v_cvt_pk_bf16_f32 v242, v68, v69
    v_cvt_pk_bf16_f32 v243, v70, v71
    s_nop 0
    v_permlane16_swap_b32 v240, v242
    v_permlane16_swap_b32 v241, v243
    buffer_store_dwordx4 v[240:243], v8, s[24:27], s42 offen offset:0 sc1
    v_lshlrev_b32 v44, 16, v196
    v_and_b32 v45, 0xffff0000, v196
    v_pk_add_f32 v[72:73], v[72:73], v[44:45]
    v_lshlrev_b32 v46, 16, v197
    v_and_b32 v47, 0xffff0000, v197
    v_pk_add_f32 v[74:75], v[74:75], v[46:47]
    v_lshlrev_b32 v48, 16, v198
    v_and_b32 v49, 0xffff0000, v198
    v_pk_add_f32 v[76:77], v[76:77], v[48:49]
    v_lshlrev_b32 v50, 16, v199
    v_and_b32 v51, 0xffff0000, v199
    v_pk_add_f32 v[78:79], v[78:79], v[50:51]
    v_cvt_pk_bf16_f32 v244, v72, v73
    v_cvt_pk_bf16_f32 v245, v74, v75
    v_cvt_pk_bf16_f32 v246, v76, v77
    v_cvt_pk_bf16_f32 v247, v78, v79
    s_nop 0
    v_permlane16_swap_b32 v244, v246
    v_permlane16_swap_b32 v245, v247
    buffer_store_dwordx4 v[244:247], v8, s[24:27], s42 offen offset:64 sc1
    v_lshlrev_b32 v44, 16, v200
    v_and_b32 v45, 0xffff0000, v200
    v_pk_add_f32 v[80:81], v[80:81], v[44:45]
    v_lshlrev_b32 v46, 16, v201
    v_and_b32 v47, 0xffff0000, v201
    v_pk_add_f32 v[82:83], v[82:83], v[46:47]
    v_lshlrev_b32 v48, 16, v202
    v_and_b32 v49, 0xffff0000, v202
    v_pk_add_f32 v[84:85], v[84:85], v[48:49]
    v_lshlrev_b32 v50, 16, v203
    v_and_b32 v51, 0xffff0000, v203
    v_pk_add_f32 v[86:87], v[86:87], v[50:51]
    v_cvt_pk_bf16_f32 v248, v80, v81
    v_cvt_pk_bf16_f32 v249, v82, v83
    v_cvt_pk_bf16_f32 v250, v84, v85
    v_cvt_pk_bf16_f32 v251, v86, v87
    s_add_u32 s42, s42, 32768
    v_permlane16_swap_b32 v248, v250
    v_permlane16_swap_b32 v249, v251
    buffer_store_dwordx4 v[248:251], v8, s[24:27], s42 offen offset:0 sc1
    v_lshlrev_b32 v44, 16, v204
    v_and_b32 v45, 0xffff0000, v204
    v_pk_add_f32 v[88:89], v[88:89], v[44:45]
    v_lshlrev_b32 v46, 16, v205
    v_and_b32 v47, 0xffff0000, v205
    v_pk_add_f32 v[90:91], v[90:91], v[46:47]
    v_lshlrev_b32 v48, 16, v206
    v_and_b32 v49, 0xffff0000, v206
    v_pk_add_f32 v[92:93], v[92:93], v[48:49]
    v_lshlrev_b32 v50, 16, v207
    v_and_b32 v51, 0xffff0000, v207
    v_pk_add_f32 v[94:95], v[94:95], v[50:51]
    v_cvt_pk_bf16_f32 v252, v88, v89
    v_cvt_pk_bf16_f32 v253, v90, v91
    v_cvt_pk_bf16_f32 v254, v92, v93
    v_cvt_pk_bf16_f32 v255, v94, v95
    s_nop 0
    v_permlane16_swap_b32 v252, v254
    v_permlane16_swap_b32 v253, v255
    buffer_store_dwordx4 v[252:255], v8, s[24:27], s42 offen offset:64 sc1
    s_branch fin_87
code_end:
.set zz0, 0
.section .rodata,"a"
.p2align 6
.amdhsa_kernel parallel_sum__spectral_gfnet__dense_activation_gelu__prompt_kernel
  .amdhsa_next_free_vgpr 256
  .amdhsa_next_free_sgpr 102
  .amdhsa_accum_offset 256
  .amdhsa_group_segment_fixed_size 0
  .amdhsa_kernarg_size 88
  .amdhsa_user_sgpr_count 2
  .amdhsa_user_sgpr_kernarg_segment_ptr 1
  .amdhsa_system_sgpr_workgroup_id_x 1
.end_amdhsa_kernel
```
